```python
import torch

def _softmax(x, axis=-1):
    return torch.softmax(x, dim=axis)
def _gelu(x):
    return torch.nn.functional.gelu(x, approximate="tanh")
def _silu(x):
    return torch.nn.functional.silu(x)
def _sigmoid(x):
    return torch.sigmoid(x)
def _layernorm(x, axis=-1, eps=1e-5):
    m = x.mean(dim=axis, keepdim=True)
    v = x.var(dim=axis, keepdim=True, unbiased=False)
    return (x - m) / torch.sqrt(v + eps)
def _scatter_add(tgt, idx, src, axis=0):
    return tgt.clone().index_add_(axis, idx, src)
def _segment_sum(src, seg, n):
    out = torch.zeros((n,) + src.shape[1:], dtype=src.dtype)
    return out.index_add_(0, seg, src)
def _pad(x, pw):
    flat = tuple(v for pair in reversed(pw) for v in pair)
    return torch.nn.functional.pad(x, flat)

kernel_name = 'concat_heads__gqa_block_cached__mha_block_cached__near_ridge'

def setup_inputs():

    _w = (lambda a: (lambda t: t.to(torch.bfloat16) if t.is_floating_point() else t)(torch.as_tensor(a)))
    def _A_setup():
        B, Sq, D = 32, 32, 512
        Hq, Hkv, Sk, Dh = 32, 32, 32, 128
        assert Hq % Hkv == 0, (Hq, Hkv)
        return {
            "x": _w((lambda *s: torch.randn(*s, dtype=torch.bfloat16) * 0.8)(B, Sq, D)),
            "k_cache": _w((lambda *s: torch.randn(*s, dtype=torch.bfloat16) * 0.8)(B, Hkv, Sk, Dh)),
            "v_cache": _w((lambda *s: torch.randn(*s, dtype=torch.bfloat16) * 0.05)(B, Hkv, Sk, Dh)),
            "wq": _w((lambda *s: torch.randn(*s, dtype=torch.bfloat16) * 0.8)(D, Hq * Dh) * (D ** -0.5)),
            "wo": _w((lambda *s: torch.randn(*s, dtype=torch.bfloat16) * 0.05)(Hq * Dh, D) * ((Hq * Dh) ** -0.5)),
        }
    _A_in = _A_setup()

    def _B_setup():
        B, Sq, D = 32, 32, 512
        H, Sk, Dh = 32, 32, 128
        return {
            "x": _w((lambda *s: torch.randn(*s, dtype=torch.bfloat16) * 0.8)(B, Sq, D)),
            "k_cache": _w((lambda *s: torch.randn(*s, dtype=torch.bfloat16) * 0.8)(B, H, Sk, Dh)),
            "v_cache": _w((lambda *s: torch.randn(*s, dtype=torch.bfloat16) * 0.05)(B, H, Sk, Dh)),
            "wq": _w((lambda *s: torch.randn(*s, dtype=torch.bfloat16) * 0.8)(D, H * Dh) * (D ** -0.5)),
            "wo": _w((lambda *s: torch.randn(*s, dtype=torch.bfloat16) * 0.05)(H * Dh, D) * ((H * Dh) ** -0.5)),
        }
    _B_in = _B_setup()

    return {
        "A_x": _A_in["x"],
        "A_k_cache": _A_in["k_cache"],
        "A_v_cache": _A_in["v_cache"],
        "A_wq": _A_in["wq"],
        "A_wo": _A_in["wo"],
        "B_x": _B_in["x"],
        "B_k_cache": _B_in["k_cache"],
        "B_v_cache": _B_in["v_cache"],
        "B_wq": _B_in["wq"],
        "B_wo": _B_in["wo"],
    }

def reference(A_x, A_k_cache, A_v_cache, A_wq, A_wo, B_x, B_k_cache, B_v_cache, B_wq, B_wo):
    def _A_ref(x, k_cache, v_cache, wq, wo):
        B, Sq, D = x.shape
        Hq, Dh = 32, 128
        Hkv = k_cache.shape[1]
        rep = Hq // Hkv
        q = (lambda x, *d: x.permute(*d))((x @ wq).reshape(B, Sq, Hq, Dh), 0, 2, 1, 3)
        k = (lambda x, n, axis: torch.repeat_interleave(x, n, dim=axis))(k_cache, rep, axis=1)
        v = (lambda x, n, axis: torch.repeat_interleave(x, n, dim=axis))(v_cache, rep, axis=1)
        scores = torch.einsum("bhqd,bhkd->bhqk", q, k) * (Dh ** -0.5)
        p = _softmax(scores, axis=-1)
        o = torch.einsum("bhqk,bhkd->bhqd", p, v)
        return (lambda x, *d: x.permute(*d))(o, 0, 2, 1, 3).reshape(B, Sq, Hq * Dh) @ wo

    def _B_ref(x, k_cache, v_cache, wq, wo):
        B, Sq, D = x.shape
        H, Dh = 32, 128
        q = (lambda x, *d: x.permute(*d))((x @ wq).reshape(B, Sq, H, Dh), 0, 2, 1, 3)
        scores = torch.einsum("bhqd,bhkd->bhqk", q, k_cache) * (Dh ** -0.5)
        p = _softmax(scores, axis=-1)
        o = torch.einsum("bhqk,bhkd->bhqd", p, v_cache)
        return (lambda x, *d: x.permute(*d))(o, 0, 2, 1, 3).reshape(B, Sq, H * Dh) @ wo

    a = _A_ref(A_x, A_k_cache, A_v_cache, A_wq, A_wo)
    b = _B_ref(B_x, B_k_cache, B_v_cache, B_wq, B_wo)
    return torch.concatenate([a, b], axis=-1)
```

```asm
; @launch kernel=main_kernel grid=(256,1,1) block=(256,1,1) lds=132096
; @launch kernel=reduce_kernel grid=(256,1,1) block=(256,1,1) lds=0
.amdgcn_target "amdgcn-amd-amdhsa--gfx950"
.text
.globl main_kernel
.p2align 8
.type main_kernel,@function
main_kernel:
    s_cmp_ge_u32 s2, 256
    s_cbranch_scc1 main_done
    s_load_dwordx16 s[16:31], s[0:1], 0
    s_load_dwordx4 s[32:35], s[0:1], 64
    s_load_dwordx2 s[36:37], s[0:1], 96
    v_lshrrev_b32 v2, 6, v0
    v_and_b32 v1, 63, v0
    v_readfirstlane_b32 s7, v2
    s_and_b32 s3, s2, 7
    s_lshr_b32 s13, s2, 3
    s_lshr_b32 s4, s3, 2
    s_and_b32 s5, s3, 3
    s_lshl_b32 s5, s5, 1
    s_and_b32 s14, s13, 1
    s_or_b32 s5, s5, s14
    s_lshr_b32 s6, s13, 1
    s_lshr_b32 s12, s2, 4
    s_and_b32 s12, s12, 3
    s_mov_b32 s74, 0x05040100
    s_mov_b32 s75, 0x07060302
    s_mov_b32 s77, 0x3db504f3
    s_mov_b32 s78, 0x3fb8aa3b
    s_mov_b32 s79, 0xffff0000
    v_and_b32 v245, 15, v1
    v_lshrrev_b32 v246, 4, v1
    v_lshlrev_b32 v247, 4, v245
    v_lshl_add_u32 v2, v246, 16, v247
    v_add_u32 v3, 0x2000, v2
    v_add_u32 v4, 0x4000, v2
    v_add_u32 v5, 0x6000, v2
    v_add_u32 v6, 0x8000, v2
    v_add_u32 v7, 0xa000, v2
    v_add_u32 v8, 0xc000, v2
    v_add_u32 v9, 0xe000, v2
    v_lshlrev_b32 v14, 8, v245
    v_lshl_add_u32 v14, v246, 6, v14
    v_lshl_add_u32 v15, v246, 10, v247
    v_lshlrev_b32 v244, 4, v1
    v_add_u32 v248, 0, v246
    v_xor_b32 v248, v248, v245
    v_lshlrev_b32 v248, 4, v248
    v_lshl_add_u32 v10, v245, 10, v248
    v_add_u32 v248, 4, v246
    v_xor_b32 v248, v248, v245
    v_lshlrev_b32 v248, 4, v248
    v_lshl_add_u32 v11, v245, 10, v248
    v_add_u32 v248, 8, v246
    v_xor_b32 v248, v248, v245
    v_lshlrev_b32 v248, 4, v248
    v_lshl_add_u32 v12, v245, 10, v248
    v_add_u32 v248, 12, v246
    v_xor_b32 v248, v248, v245
    v_lshlrev_b32 v248, 4, v248
    v_lshl_add_u32 v13, v245, 10, v248
    v_lshrrev_b32 v249, 3, v1
    v_and_b32 v248, 7, v1
    v_lshlrev_b32 v248, 7, v248
    v_lshl_add_u32 v249, v249, 13, v248
    v_lshlrev_b32 v250, 7, v1
    s_waitcnt lgkmcnt(0)
    s_cmp_eq_u32 s4, 0
    s_cselect_b64 s[40:41], s[16:17], s[26:27]
    s_cselect_b64 s[44:45], s[18:19], s[28:29]
    s_cselect_b64 s[48:49], s[20:21], s[30:31]
    s_cselect_b64 s[52:53], s[22:23], s[32:33]
    s_cselect_b64 s[56:57], s[24:25], s[34:35]
    s_cselect_b64 s[64:65], s[22:23], s[32:33]
    s_mov_b64 s[60:61], s[36:37]
    s_mov_b32 s42, 0x100000
    s_mov_b32 s43, 0x00020000
    s_mov_b32 s46, 0x800000
    s_mov_b32 s47, 0x00020000
    s_mov_b32 s50, 0x800000
    s_mov_b32 s51, 0x00020000
    s_mov_b32 s54, 0x400000
    s_mov_b32 s55, 0x00020000
    s_mov_b32 s58, 0x400000
    s_mov_b32 s59, 0x00020000
    s_mov_b32 s62, 0x2000000
    s_mov_b32 s63, 0x00020000
    s_mov_b32 s66, 0x400000
    s_mov_b32 s67, 0x00020000
    s_lshl_b32 s9, s5, 2
    s_add_u32 s9, s9, s7
    s_lshl_b32 s68, s9, 8
    s_mov_b32 s69, 0x40000
    s_lshl_b32 s11, s5, 19
    s_lshl_b32 s3, s7, 8
    s_add_u32 s11, s11, s3
    s_lshl_b32 s3, s6, 6
    s_add_u32 s3, s3, s9
    s_lshl_b32 s70, s3, 13
    s_add_u32 s71, s70, 0x1000
    s_add_u32 s72, s70, 0x40000
    s_add_u32 s73, s70, 0x41000
    s_lshl_b32 s8, s6, 16
    s_lshl_b32 s3, s7, 14
    s_add_u32 s8, s8, s3
    s_lshl_b32 s3, s4, 4
    s_add_u32 s3, s3, s6
    s_lshl_b32 s3, s3, 3
    s_add_u32 s3, s3, s5
    s_lshl_b32 s3, s3, 2
    s_add_u32 s3, s3, s7
    s_lshl_b32 s76, s3, 15
    s_lshl_b32 s13, s6, 2
    s_add_u32 s13, s13, s7
    s_lshl_b32 s14, s13, 16
    s_lshl_b32 s3, s5, 10
    s_add_u32 s14, s14, s3
    buffer_load_dword v251, v249, s[52:55], s14 offen
    buffer_load_dwordx4 v[176:179], v244, s[40:43], s8 offen offset:0
    buffer_load_dwordx4 v[180:183], v244, s[40:43], s8 offen offset:1024
    buffer_load_dwordx4 v[184:187], v244, s[40:43], s8 offen offset:2048
    buffer_load_dwordx4 v[188:191], v244, s[40:43], s8 offen offset:3072
    s_add_u32 s8, s8, 0x1000
    buffer_load_dwordx4 v[192:195], v244, s[40:43], s8 offen offset:0
    buffer_load_dwordx4 v[196:199], v244, s[40:43], s8 offen offset:1024
    buffer_load_dwordx4 v[200:203], v244, s[40:43], s8 offen offset:2048
    buffer_load_dwordx4 v[204:207], v244, s[40:43], s8 offen offset:3072
    s_add_u32 s8, s8, 0x1000
    buffer_load_dwordx4 v[208:211], v244, s[40:43], s8 offen offset:0
    buffer_load_dwordx4 v[212:215], v244, s[40:43], s8 offen offset:1024
    buffer_load_dwordx4 v[216:219], v244, s[40:43], s8 offen offset:2048
    buffer_load_dwordx4 v[220:223], v244, s[40:43], s8 offen offset:3072
    s_add_u32 s8, s8, 0x1000
    buffer_load_dwordx4 v[224:227], v244, s[40:43], s8 offen offset:0
    buffer_load_dwordx4 v[228:231], v244, s[40:43], s8 offen offset:1024
    buffer_load_dwordx4 v[232:235], v244, s[40:43], s8 offen offset:2048
    buffer_load_dwordx4 v[236:239], v244, s[40:43], s8 offen offset:3072
    buffer_load_dwordx4 v[16:19], v2, s[64:67], s68 offen
    buffer_load_dwordx4 v[20:23], v3, s[64:67], s68 offen
    buffer_load_dwordx4 v[24:27], v4, s[64:67], s68 offen
    buffer_load_dwordx4 v[28:31], v5, s[64:67], s68 offen
    buffer_load_dwordx4 v[32:35], v6, s[64:67], s68 offen
    buffer_load_dwordx4 v[36:39], v7, s[64:67], s68 offen
    buffer_load_dwordx4 v[40:43], v8, s[64:67], s68 offen
    buffer_load_dwordx4 v[44:47], v9, s[64:67], s68 offen
    s_add_u32 s68, s68, s69
    buffer_load_dwordx4 v[48:51], v2, s[64:67], s68 offen
    buffer_load_dwordx4 v[52:55], v3, s[64:67], s68 offen
    buffer_load_dwordx4 v[56:59], v4, s[64:67], s68 offen
    buffer_load_dwordx4 v[60:63], v5, s[64:67], s68 offen
    buffer_load_dwordx4 v[64:67], v6, s[64:67], s68 offen
    buffer_load_dwordx4 v[68:71], v7, s[64:67], s68 offen
    buffer_load_dwordx4 v[72:75], v8, s[64:67], s68 offen
    buffer_load_dwordx4 v[76:79], v9, s[64:67], s68 offen
    s_add_u32 s68, s68, s69
    v_mov_b32 v144, 0
    v_mov_b32 v145, 0
    v_mov_b32 v146, 0
    v_mov_b32 v147, 0
    s_nop 1
    v_mfma_f32_16x16x32_bf16 a[0:3], v[144:147], v[144:147], 0
    v_mfma_f32_16x16x32_bf16 a[4:7], v[144:147], v[144:147], 0
    v_mfma_f32_16x16x32_bf16 a[8:11], v[144:147], v[144:147], 0
    v_mfma_f32_16x16x32_bf16 a[12:15], v[144:147], v[144:147], 0
    v_mfma_f32_16x16x32_bf16 a[16:19], v[144:147], v[144:147], 0
    v_mfma_f32_16x16x32_bf16 a[20:23], v[144:147], v[144:147], 0
    v_mfma_f32_16x16x32_bf16 a[24:27], v[144:147], v[144:147], 0
    v_mfma_f32_16x16x32_bf16 a[28:31], v[144:147], v[144:147], 0
    v_mfma_f32_16x16x32_bf16 a[32:35], v[144:147], v[144:147], 0
    v_mfma_f32_16x16x32_bf16 a[36:39], v[144:147], v[144:147], 0
    v_mfma_f32_16x16x32_bf16 a[40:43], v[144:147], v[144:147], 0
    v_mfma_f32_16x16x32_bf16 a[44:47], v[144:147], v[144:147], 0
    v_mfma_f32_16x16x32_bf16 a[48:51], v[144:147], v[144:147], 0
    v_mfma_f32_16x16x32_bf16 a[52:55], v[144:147], v[144:147], 0
    v_mfma_f32_16x16x32_bf16 a[56:59], v[144:147], v[144:147], 0
    v_mfma_f32_16x16x32_bf16 a[60:63], v[144:147], v[144:147], 0
    v_mfma_f32_16x16x32_bf16 a[64:67], v[144:147], v[144:147], 0
    v_mfma_f32_16x16x32_bf16 a[68:71], v[144:147], v[144:147], 0
    v_mfma_f32_16x16x32_bf16 a[72:75], v[144:147], v[144:147], 0
    v_mfma_f32_16x16x32_bf16 a[76:79], v[144:147], v[144:147], 0
    v_mfma_f32_16x16x32_bf16 a[80:83], v[144:147], v[144:147], 0
    v_mfma_f32_16x16x32_bf16 a[84:87], v[144:147], v[144:147], 0
    v_mfma_f32_16x16x32_bf16 a[88:91], v[144:147], v[144:147], 0
    v_mfma_f32_16x16x32_bf16 a[92:95], v[144:147], v[144:147], 0
    v_mfma_f32_16x16x32_bf16 a[96:99], v[144:147], v[144:147], 0
    v_mfma_f32_16x16x32_bf16 a[100:103], v[144:147], v[144:147], 0
    v_mfma_f32_16x16x32_bf16 a[104:107], v[144:147], v[144:147], 0
    v_mfma_f32_16x16x32_bf16 a[108:111], v[144:147], v[144:147], 0
    v_mfma_f32_16x16x32_bf16 a[112:115], v[144:147], v[144:147], 0
    v_mfma_f32_16x16x32_bf16 a[116:119], v[144:147], v[144:147], 0
    v_mfma_f32_16x16x32_bf16 a[120:123], v[144:147], v[144:147], 0
    v_mfma_f32_16x16x32_bf16 a[124:127], v[144:147], v[144:147], 0
    v_mov_b32 v253, s7
    v_lshlrev_b32 v253, 14, v253
    s_waitcnt vmcnt(16)
    v_xor_b32 v254, 0, v1
    v_lshl_add_u32 v254, v254, 4, v253
    ds_write_b128 v254, v[176:179] offset:0
    v_xor_b32 v255, 1, v1
    v_lshl_add_u32 v255, v255, 4, v253
    ds_write_b128 v255, v[180:183] offset:1024
    v_xor_b32 v254, 2, v1
    v_lshl_add_u32 v254, v254, 4, v253
    ds_write_b128 v254, v[184:187] offset:2048
    v_xor_b32 v255, 3, v1
    v_lshl_add_u32 v255, v255, 4, v253
    ds_write_b128 v255, v[188:191] offset:3072
    v_xor_b32 v254, 4, v1
    v_lshl_add_u32 v254, v254, 4, v253
    ds_write_b128 v254, v[192:195] offset:4096
    v_xor_b32 v255, 5, v1
    v_lshl_add_u32 v255, v255, 4, v253
    ds_write_b128 v255, v[196:199] offset:5120
    v_xor_b32 v254, 6, v1
    v_lshl_add_u32 v254, v254, 4, v253
    ds_write_b128 v254, v[200:203] offset:6144
    v_xor_b32 v255, 7, v1
    v_lshl_add_u32 v255, v255, 4, v253
    ds_write_b128 v255, v[204:207] offset:7168
    v_xor_b32 v254, 8, v1
    v_lshl_add_u32 v254, v254, 4, v253
    ds_write_b128 v254, v[208:211] offset:8192
    v_xor_b32 v255, 9, v1
    v_lshl_add_u32 v255, v255, 4, v253
    ds_write_b128 v255, v[212:215] offset:9216
    v_xor_b32 v254, 10, v1
    v_lshl_add_u32 v254, v254, 4, v253
    ds_write_b128 v254, v[216:219] offset:10240
    v_xor_b32 v255, 11, v1
    v_lshl_add_u32 v255, v255, 4, v253
    ds_write_b128 v255, v[220:223] offset:11264
    v_xor_b32 v254, 12, v1
    v_lshl_add_u32 v254, v254, 4, v253
    ds_write_b128 v254, v[224:227] offset:12288
    v_xor_b32 v255, 13, v1
    v_lshl_add_u32 v255, v255, 4, v253
    ds_write_b128 v255, v[228:231] offset:13312
    v_xor_b32 v254, 14, v1
    v_lshl_add_u32 v254, v254, 4, v253
    ds_write_b128 v254, v[232:235] offset:14336
    v_xor_b32 v255, 15, v1
    v_lshl_add_u32 v255, v255, 4, v253
    ds_write_b128 v255, v[236:239] offset:15360
    buffer_load_dwordx4 v[80:83], v2, s[64:67], s68 offen
    buffer_load_dwordx4 v[84:87], v3, s[64:67], s68 offen
    buffer_load_dwordx4 v[88:91], v4, s[64:67], s68 offen
    buffer_load_dwordx4 v[92:95], v5, s[64:67], s68 offen
    buffer_load_dwordx4 v[96:99], v6, s[64:67], s68 offen
    buffer_load_dwordx4 v[100:103], v7, s[64:67], s68 offen
    buffer_load_dwordx4 v[104:107], v8, s[64:67], s68 offen
    buffer_load_dwordx4 v[108:111], v9, s[64:67], s68 offen
    s_add_u32 s68, s68, s69
    buffer_load_dwordx4 v[112:115], v2, s[64:67], s68 offen
    buffer_load_dwordx4 v[116:119], v3, s[64:67], s68 offen
    buffer_load_dwordx4 v[120:123], v4, s[64:67], s68 offen
    buffer_load_dwordx4 v[124:127], v5, s[64:67], s68 offen
    buffer_load_dwordx4 v[128:131], v6, s[64:67], s68 offen
    buffer_load_dwordx4 v[132:135], v7, s[64:67], s68 offen
    buffer_load_dwordx4 v[136:139], v8, s[64:67], s68 offen
    buffer_load_dwordx4 v[140:143], v9, s[64:67], s68 offen
    s_add_u32 s68, s68, s69
    s_lshl_b32 s14, s5, 19
    s_lshl_b32 s3, s13, 13
    s_add_u32 s14, s14, s3
    s_waitcnt lgkmcnt(0)
    s_barrier
    s_mov_b32 s10, 0
    ds_read_b128 a[128:131], v10 offset:0
    ds_read_b128 a[132:135], v10 offset:16384
    ds_read_b128 a[136:139], v10 offset:32768
    ds_read_b128 a[140:143], v10 offset:49152
    s_waitcnt vmcnt(24)
    v_perm_b32 v144, v20, v16, s74
    v_perm_b32 v145, v28, v24, s74
    v_perm_b32 v146, v36, v32, s74
    v_perm_b32 v147, v44, v40, s74
    v_perm_b32 v148, v20, v16, s75
    v_perm_b32 v149, v28, v24, s75
    v_perm_b32 v150, v36, v32, s75
    v_perm_b32 v151, v44, v40, s75
    v_perm_b32 v152, v21, v17, s74
    v_perm_b32 v153, v29, v25, s74
    v_perm_b32 v154, v37, v33, s74
    v_perm_b32 v155, v45, v41, s74
    v_perm_b32 v156, v21, v17, s75
    v_perm_b32 v157, v29, v25, s75
    v_perm_b32 v158, v37, v33, s75
    v_perm_b32 v159, v45, v41, s75
    v_perm_b32 v160, v22, v18, s74
    v_perm_b32 v161, v30, v26, s74
    v_perm_b32 v162, v38, v34, s74
    v_perm_b32 v163, v46, v42, s74
    v_perm_b32 v164, v22, v18, s75
    v_perm_b32 v165, v30, v26, s75
    v_perm_b32 v166, v38, v34, s75
    v_perm_b32 v167, v46, v42, s75
    v_perm_b32 v168, v23, v19, s74
    v_perm_b32 v169, v31, v27, s74
    v_perm_b32 v170, v39, v35, s74
    v_perm_b32 v171, v47, v43, s74
    v_perm_b32 v172, v23, v19, s75
    v_perm_b32 v173, v31, v27, s75
    v_perm_b32 v174, v39, v35, s75
    v_perm_b32 v175, v47, v43, s75
gemm_loop:
    s_nop 1
    s_waitcnt lgkmcnt(0)
    v_mfma_f32_16x16x32_bf16 a[0:3], v[144:147], a[128:131], a[0:3]
    buffer_load_dwordx4 v[16:19], v2, s[64:67], s68 offen
    buffer_load_dwordx4 v[20:23], v3, s[64:67], s68 offen
    v_mfma_f32_16x16x32_bf16 a[32:35], v[144:147], a[132:135], a[32:35]
    buffer_load_dwordx4 v[24:27], v4, s[64:67], s68 offen
    buffer_load_dwordx4 v[28:31], v5, s[64:67], s68 offen
    v_mfma_f32_16x16x32_bf16 a[64:67], v[144:147], a[136:139], a[64:67]
    buffer_load_dwordx4 v[32:35], v6, s[64:67], s68 offen
    buffer_load_dwordx4 v[36:39], v7, s[64:67], s68 offen
    v_mfma_f32_16x16x32_bf16 a[96:99], v[144:147], a[140:143], a[96:99]
    buffer_load_dwordx4 v[40:43], v8, s[64:67], s68 offen
    buffer_load_dwordx4 v[44:47], v9, s[64:67], s68 offen
    s_add_u32 s68, s68, s69
    s_waitcnt vmcnt(24)
    v_mfma_f32_16x16x32_bf16 a[4:7], v[148:151], a[128:131], a[4:7]
    v_perm_b32 v144, v52, v48, s74
    v_mfma_f32_16x16x32_bf16 a[36:39], v[148:151], a[132:135], a[36:39]
    v_perm_b32 v145, v60, v56, s74
    v_mfma_f32_16x16x32_bf16 a[68:71], v[148:151], a[136:139], a[68:71]
    v_perm_b32 v146, v68, v64, s74
    v_mfma_f32_16x16x32_bf16 a[100:103], v[148:151], a[140:143], a[100:103]
    v_perm_b32 v147, v76, v72, s74
    v_mfma_f32_16x16x32_bf16 a[8:11], v[152:155], a[128:131], a[8:11]
    v_perm_b32 v148, v52, v48, s75
    ds_read_b128 a[144:147], v11 offset:0
    v_mfma_f32_16x16x32_bf16 a[40:43], v[152:155], a[132:135], a[40:43]
    v_perm_b32 v149, v60, v56, s75
    ds_read_b128 a[148:151], v11 offset:16384
    v_mfma_f32_16x16x32_bf16 a[72:75], v[152:155], a[136:139], a[72:75]
    v_perm_b32 v150, v68, v64, s75
    ds_read_b128 a[152:155], v11 offset:32768
    v_mfma_f32_16x16x32_bf16 a[104:107], v[152:155], a[140:143], a[104:107]
    v_perm_b32 v151, v76, v72, s75
    ds_read_b128 a[156:159], v11 offset:49152
    v_mfma_f32_16x16x32_bf16 a[12:15], v[156:159], a[128:131], a[12:15]
    v_perm_b32 v152, v53, v49, s74
    v_mfma_f32_16x16x32_bf16 a[44:47], v[156:159], a[132:135], a[44:47]
    v_perm_b32 v153, v61, v57, s74
    v_mfma_f32_16x16x32_bf16 a[76:79], v[156:159], a[136:139], a[76:79]
    v_perm_b32 v154, v69, v65, s74
    v_mfma_f32_16x16x32_bf16 a[108:111], v[156:159], a[140:143], a[108:111]
    v_perm_b32 v155, v77, v73, s74
    v_mfma_f32_16x16x32_bf16 a[16:19], v[160:163], a[128:131], a[16:19]
    v_perm_b32 v156, v53, v49, s75
    v_mfma_f32_16x16x32_bf16 a[48:51], v[160:163], a[132:135], a[48:51]
    v_perm_b32 v157, v61, v57, s75
    v_mfma_f32_16x16x32_bf16 a[80:83], v[160:163], a[136:139], a[80:83]
    v_perm_b32 v158, v69, v65, s75
    v_mfma_f32_16x16x32_bf16 a[112:115], v[160:163], a[140:143], a[112:115]
    v_perm_b32 v159, v77, v73, s75
    v_mfma_f32_16x16x32_bf16 a[20:23], v[164:167], a[128:131], a[20:23]
    v_perm_b32 v160, v54, v50, s74
    v_mfma_f32_16x16x32_bf16 a[52:55], v[164:167], a[132:135], a[52:55]
    v_perm_b32 v161, v62, v58, s74
    v_mfma_f32_16x16x32_bf16 a[84:87], v[164:167], a[136:139], a[84:87]
    v_perm_b32 v162, v70, v66, s74
    v_mfma_f32_16x16x32_bf16 a[116:119], v[164:167], a[140:143], a[116:119]
    v_perm_b32 v163, v78, v74, s74
    v_mfma_f32_16x16x32_bf16 a[24:27], v[168:171], a[128:131], a[24:27]
    v_perm_b32 v164, v54, v50, s75
    v_mfma_f32_16x16x32_bf16 a[56:59], v[168:171], a[132:135], a[56:59]
    v_perm_b32 v165, v62, v58, s75
    v_mfma_f32_16x16x32_bf16 a[88:91], v[168:171], a[136:139], a[88:91]
    v_perm_b32 v166, v70, v66, s75
    v_mfma_f32_16x16x32_bf16 a[120:123], v[168:171], a[140:143], a[120:123]
    v_perm_b32 v167, v78, v74, s75
    v_mfma_f32_16x16x32_bf16 a[28:31], v[172:175], a[128:131], a[28:31]
    v_perm_b32 v168, v55, v51, s74
    v_mfma_f32_16x16x32_bf16 a[60:63], v[172:175], a[132:135], a[60:63]
    v_perm_b32 v169, v63, v59, s74
    v_mfma_f32_16x16x32_bf16 a[92:95], v[172:175], a[136:139], a[92:95]
    v_perm_b32 v170, v71, v67, s74
    v_mfma_f32_16x16x32_bf16 a[124:127], v[172:175], a[140:143], a[124:127]
    v_perm_b32 v171, v79, v75, s74
    v_perm_b32 v172, v55, v51, s75
    v_perm_b32 v173, v63, v59, s75
    v_perm_b32 v174, v71, v67, s75
    v_perm_b32 v175, v79, v75, s75
    s_waitcnt lgkmcnt(0)
    v_mfma_f32_16x16x32_bf16 a[0:3], v[144:147], a[144:147], a[0:3]
    buffer_load_dwordx4 v[48:51], v2, s[64:67], s68 offen
    buffer_load_dwordx4 v[52:55], v3, s[64:67], s68 offen
    v_mfma_f32_16x16x32_bf16 a[32:35], v[144:147], a[148:151], a[32:35]
    buffer_load_dwordx4 v[56:59], v4, s[64:67], s68 offen
    buffer_load_dwordx4 v[60:63], v5, s[64:67], s68 offen
    v_mfma_f32_16x16x32_bf16 a[64:67], v[144:147], a[152:155], a[64:67]
    buffer_load_dwordx4 v[64:67], v6, s[64:67], s68 offen
    buffer_load_dwordx4 v[68:71], v7, s[64:67], s68 offen
    v_mfma_f32_16x16x32_bf16 a[96:99], v[144:147], a[156:159], a[96:99]
    buffer_load_dwordx4 v[72:75], v8, s[64:67], s68 offen
    buffer_load_dwordx4 v[76:79], v9, s[64:67], s68 offen
    s_add_u32 s68, s68, s69
    s_waitcnt vmcnt(24)
    v_mfma_f32_16x16x32_bf16 a[4:7], v[148:151], a[144:147], a[4:7]
    v_perm_b32 v144, v84, v80, s74
    v_mfma_f32_16x16x32_bf16 a[36:39], v[148:151], a[148:151], a[36:39]
    v_perm_b32 v145, v92, v88, s74
    v_mfma_f32_16x16x32_bf16 a[68:71], v[148:151], a[152:155], a[68:71]
    v_perm_b32 v146, v100, v96, s74
    v_mfma_f32_16x16x32_bf16 a[100:103], v[148:151], a[156:159], a[100:103]
    v_perm_b32 v147, v108, v104, s74
    v_mfma_f32_16x16x32_bf16 a[8:11], v[152:155], a[144:147], a[8:11]
    v_perm_b32 v148, v84, v80, s75
    ds_read_b128 a[128:131], v12 offset:0
    v_mfma_f32_16x16x32_bf16 a[40:43], v[152:155], a[148:151], a[40:43]
    v_perm_b32 v149, v92, v88, s75
    ds_read_b128 a[132:135], v12 offset:16384
    v_mfma_f32_16x16x32_bf16 a[72:75], v[152:155], a[152:155], a[72:75]
    v_perm_b32 v150, v100, v96, s75
    ds_read_b128 a[136:139], v12 offset:32768
    v_mfma_f32_16x16x32_bf16 a[104:107], v[152:155], a[156:159], a[104:107]
    v_perm_b32 v151, v108, v104, s75
    ds_read_b128 a[140:143], v12 offset:49152
    v_mfma_f32_16x16x32_bf16 a[12:15], v[156:159], a[144:147], a[12:15]
    v_perm_b32 v152, v85, v81, s74
    v_mfma_f32_16x16x32_bf16 a[44:47], v[156:159], a[148:151], a[44:47]
    v_perm_b32 v153, v93, v89, s74
    v_mfma_f32_16x16x32_bf16 a[76:79], v[156:159], a[152:155], a[76:79]
    v_perm_b32 v154, v101, v97, s74
    v_mfma_f32_16x16x32_bf16 a[108:111], v[156:159], a[156:159], a[108:111]
    v_perm_b32 v155, v109, v105, s74
    v_mfma_f32_16x16x32_bf16 a[16:19], v[160:163], a[144:147], a[16:19]
    v_perm_b32 v156, v85, v81, s75
    v_mfma_f32_16x16x32_bf16 a[48:51], v[160:163], a[148:151], a[48:51]
    v_perm_b32 v157, v93, v89, s75
    v_mfma_f32_16x16x32_bf16 a[80:83], v[160:163], a[152:155], a[80:83]
    v_perm_b32 v158, v101, v97, s75
    v_mfma_f32_16x16x32_bf16 a[112:115], v[160:163], a[156:159], a[112:115]
    v_perm_b32 v159, v109, v105, s75
    v_mfma_f32_16x16x32_bf16 a[20:23], v[164:167], a[144:147], a[20:23]
    v_perm_b32 v160, v86, v82, s74
    v_mfma_f32_16x16x32_bf16 a[52:55], v[164:167], a[148:151], a[52:55]
    v_perm_b32 v161, v94, v90, s74
    v_mfma_f32_16x16x32_bf16 a[84:87], v[164:167], a[152:155], a[84:87]
    v_perm_b32 v162, v102, v98, s74
    v_mfma_f32_16x16x32_bf16 a[116:119], v[164:167], a[156:159], a[116:119]
    v_perm_b32 v163, v110, v106, s74
    v_mfma_f32_16x16x32_bf16 a[24:27], v[168:171], a[144:147], a[24:27]
    v_perm_b32 v164, v86, v82, s75
    v_mfma_f32_16x16x32_bf16 a[56:59], v[168:171], a[148:151], a[56:59]
    v_perm_b32 v165, v94, v90, s75
    v_mfma_f32_16x16x32_bf16 a[88:91], v[168:171], a[152:155], a[88:91]
    v_perm_b32 v166, v102, v98, s75
    v_mfma_f32_16x16x32_bf16 a[120:123], v[168:171], a[156:159], a[120:123]
    v_perm_b32 v167, v110, v106, s75
    v_mfma_f32_16x16x32_bf16 a[28:31], v[172:175], a[144:147], a[28:31]
    v_perm_b32 v168, v87, v83, s74
    v_mfma_f32_16x16x32_bf16 a[60:63], v[172:175], a[148:151], a[60:63]
    v_perm_b32 v169, v95, v91, s74
    v_mfma_f32_16x16x32_bf16 a[92:95], v[172:175], a[152:155], a[92:95]
    v_perm_b32 v170, v103, v99, s74
    v_mfma_f32_16x16x32_bf16 a[124:127], v[172:175], a[156:159], a[124:127]
    v_perm_b32 v171, v111, v107, s74
    v_perm_b32 v172, v87, v83, s75
    v_perm_b32 v173, v95, v91, s75
    v_perm_b32 v174, v103, v99, s75
    v_perm_b32 v175, v111, v107, s75
    s_waitcnt lgkmcnt(0)
    s_cmp_eq_u32 s10, 3
    s_cselect_b32 s66, 0, s66
    v_mfma_f32_16x16x32_bf16 a[0:3], v[144:147], a[128:131], a[0:3]
    buffer_load_dwordx4 v[80:83], v2, s[64:67], s68 offen
    buffer_load_dwordx4 v[84:87], v3, s[64:67], s68 offen
    v_mfma_f32_16x16x32_bf16 a[32:35], v[144:147], a[132:135], a[32:35]
    buffer_load_dwordx4 v[88:91], v4, s[64:67], s68 offen
    buffer_load_dwordx4 v[92:95], v5, s[64:67], s68 offen
    v_mfma_f32_16x16x32_bf16 a[64:67], v[144:147], a[136:139], a[64:67]
    buffer_load_dwordx4 v[96:99], v6, s[64:67], s68 offen
    buffer_load_dwordx4 v[100:103], v7, s[64:67], s68 offen
    v_mfma_f32_16x16x32_bf16 a[96:99], v[144:147], a[140:143], a[96:99]
    buffer_load_dwordx4 v[104:107], v8, s[64:67], s68 offen
    buffer_load_dwordx4 v[108:111], v9, s[64:67], s68 offen
    s_add_u32 s68, s68, s69
    s_waitcnt vmcnt(24)
    v_mfma_f32_16x16x32_bf16 a[4:7], v[148:151], a[128:131], a[4:7]
    v_perm_b32 v144, v116, v112, s74
    v_mfma_f32_16x16x32_bf16 a[36:39], v[148:151], a[132:135], a[36:39]
    v_perm_b32 v145, v124, v120, s74
    v_mfma_f32_16x16x32_bf16 a[68:71], v[148:151], a[136:139], a[68:71]
    v_perm_b32 v146, v132, v128, s74
    v_mfma_f32_16x16x32_bf16 a[100:103], v[148:151], a[140:143], a[100:103]
    v_perm_b32 v147, v140, v136, s74
    v_mfma_f32_16x16x32_bf16 a[8:11], v[152:155], a[128:131], a[8:11]
    v_perm_b32 v148, v116, v112, s75
    ds_read_b128 a[144:147], v13 offset:0
    v_mfma_f32_16x16x32_bf16 a[40:43], v[152:155], a[132:135], a[40:43]
    v_perm_b32 v149, v124, v120, s75
    ds_read_b128 a[148:151], v13 offset:16384
    v_mfma_f32_16x16x32_bf16 a[72:75], v[152:155], a[136:139], a[72:75]
    v_perm_b32 v150, v132, v128, s75
    ds_read_b128 a[152:155], v13 offset:32768
    v_mfma_f32_16x16x32_bf16 a[104:107], v[152:155], a[140:143], a[104:107]
    v_perm_b32 v151, v140, v136, s75
    ds_read_b128 a[156:159], v13 offset:49152
    v_mfma_f32_16x16x32_bf16 a[12:15], v[156:159], a[128:131], a[12:15]
    v_perm_b32 v152, v117, v113, s74
    v_mfma_f32_16x16x32_bf16 a[44:47], v[156:159], a[132:135], a[44:47]
    v_perm_b32 v153, v125, v121, s74
    v_mfma_f32_16x16x32_bf16 a[76:79], v[156:159], a[136:139], a[76:79]
    v_perm_b32 v154, v133, v129, s74
    v_mfma_f32_16x16x32_bf16 a[108:111], v[156:159], a[140:143], a[108:111]
    v_perm_b32 v155, v141, v137, s74
    v_mfma_f32_16x16x32_bf16 a[16:19], v[160:163], a[128:131], a[16:19]
    v_perm_b32 v156, v117, v113, s75
    v_mfma_f32_16x16x32_bf16 a[48:51], v[160:163], a[132:135], a[48:51]
    v_perm_b32 v157, v125, v121, s75
    v_mfma_f32_16x16x32_bf16 a[80:83], v[160:163], a[136:139], a[80:83]
    v_perm_b32 v158, v133, v129, s75
    v_mfma_f32_16x16x32_bf16 a[112:115], v[160:163], a[140:143], a[112:115]
    v_perm_b32 v159, v141, v137, s75
    v_mfma_f32_16x16x32_bf16 a[20:23], v[164:167], a[128:131], a[20:23]
    v_perm_b32 v160, v118, v114, s74
    v_mfma_f32_16x16x32_bf16 a[52:55], v[164:167], a[132:135], a[52:55]
    v_perm_b32 v161, v126, v122, s74
    v_mfma_f32_16x16x32_bf16 a[84:87], v[164:167], a[136:139], a[84:87]
    v_perm_b32 v162, v134, v130, s74
    v_mfma_f32_16x16x32_bf16 a[116:119], v[164:167], a[140:143], a[116:119]
    v_perm_b32 v163, v142, v138, s74
    v_mfma_f32_16x16x32_bf16 a[24:27], v[168:171], a[128:131], a[24:27]
    v_perm_b32 v164, v118, v114, s75
    v_mfma_f32_16x16x32_bf16 a[56:59], v[168:171], a[132:135], a[56:59]
    v_perm_b32 v165, v126, v122, s75
    v_mfma_f32_16x16x32_bf16 a[88:91], v[168:171], a[136:139], a[88:91]
    v_perm_b32 v166, v134, v130, s75
    v_mfma_f32_16x16x32_bf16 a[120:123], v[168:171], a[140:143], a[120:123]
    v_perm_b32 v167, v142, v138, s75
    v_mfma_f32_16x16x32_bf16 a[28:31], v[172:175], a[128:131], a[28:31]
    v_perm_b32 v168, v119, v115, s74
    v_mfma_f32_16x16x32_bf16 a[60:63], v[172:175], a[132:135], a[60:63]
    v_perm_b32 v169, v127, v123, s74
    v_mfma_f32_16x16x32_bf16 a[92:95], v[172:175], a[136:139], a[92:95]
    v_perm_b32 v170, v135, v131, s74
    v_mfma_f32_16x16x32_bf16 a[124:127], v[172:175], a[140:143], a[124:127]
    v_perm_b32 v171, v143, v139, s74
    v_perm_b32 v172, v119, v115, s75
    v_perm_b32 v173, v127, v123, s75
    v_perm_b32 v174, v135, v131, s75
    v_perm_b32 v175, v143, v139, s75
    s_waitcnt lgkmcnt(0)
    v_mfma_f32_16x16x32_bf16 a[0:3], v[144:147], a[144:147], a[0:3]
    buffer_load_dwordx4 v[112:115], v2, s[64:67], s68 offen
    buffer_load_dwordx4 v[116:119], v3, s[64:67], s68 offen
    v_mfma_f32_16x16x32_bf16 a[32:35], v[144:147], a[148:151], a[32:35]
    buffer_load_dwordx4 v[120:123], v4, s[64:67], s68 offen
    buffer_load_dwordx4 v[124:127], v5, s[64:67], s68 offen
    v_mfma_f32_16x16x32_bf16 a[64:67], v[144:147], a[152:155], a[64:67]
    buffer_load_dwordx4 v[128:131], v6, s[64:67], s68 offen
    buffer_load_dwordx4 v[132:135], v7, s[64:67], s68 offen
    v_mfma_f32_16x16x32_bf16 a[96:99], v[144:147], a[156:159], a[96:99]
    buffer_load_dwordx4 v[136:139], v8, s[64:67], s68 offen
    buffer_load_dwordx4 v[140:143], v9, s[64:67], s68 offen
    s_add_u32 s68, s68, s69
    s_waitcnt vmcnt(24)
    v_mfma_f32_16x16x32_bf16 a[4:7], v[148:151], a[144:147], a[4:7]
    v_perm_b32 v144, v20, v16, s74
    v_mfma_f32_16x16x32_bf16 a[36:39], v[148:151], a[148:151], a[36:39]
    v_perm_b32 v145, v28, v24, s74
    v_mfma_f32_16x16x32_bf16 a[68:71], v[148:151], a[152:155], a[68:71]
    v_perm_b32 v146, v36, v32, s74
    v_mfma_f32_16x16x32_bf16 a[100:103], v[148:151], a[156:159], a[100:103]
    v_perm_b32 v147, v44, v40, s74
    v_mfma_f32_16x16x32_bf16 a[8:11], v[152:155], a[144:147], a[8:11]
    v_perm_b32 v148, v20, v16, s75
    ds_read_b128 a[128:131], v10 offset:256
    v_mfma_f32_16x16x32_bf16 a[40:43], v[152:155], a[148:151], a[40:43]
    v_perm_b32 v149, v28, v24, s75
    ds_read_b128 a[132:135], v10 offset:16640
    v_mfma_f32_16x16x32_bf16 a[72:75], v[152:155], a[152:155], a[72:75]
    v_perm_b32 v150, v36, v32, s75
    ds_read_b128 a[136:139], v10 offset:33024
    v_mfma_f32_16x16x32_bf16 a[104:107], v[152:155], a[156:159], a[104:107]
    v_perm_b32 v151, v44, v40, s75
    ds_read_b128 a[140:143], v10 offset:49408
    v_mfma_f32_16x16x32_bf16 a[12:15], v[156:159], a[144:147], a[12:15]
    v_perm_b32 v152, v21, v17, s74
    v_mfma_f32_16x16x32_bf16 a[44:47], v[156:159], a[148:151], a[44:47]
    v_perm_b32 v153, v29, v25, s74
    v_mfma_f32_16x16x32_bf16 a[76:79], v[156:159], a[152:155], a[76:79]
    v_perm_b32 v154, v37, v33, s74
    v_mfma_f32_16x16x32_bf16 a[108:111], v[156:159], a[156:159], a[108:111]
    v_perm_b32 v155, v45, v41, s74
    v_mfma_f32_16x16x32_bf16 a[16:19], v[160:163], a[144:147], a[16:19]
    v_perm_b32 v156, v21, v17, s75
    v_mfma_f32_16x16x32_bf16 a[48:51], v[160:163], a[148:151], a[48:51]
    v_perm_b32 v157, v29, v25, s75
    v_mfma_f32_16x16x32_bf16 a[80:83], v[160:163], a[152:155], a[80:83]
    v_perm_b32 v158, v37, v33, s75
    v_mfma_f32_16x16x32_bf16 a[112:115], v[160:163], a[156:159], a[112:115]
    v_perm_b32 v159, v45, v41, s75
    v_mfma_f32_16x16x32_bf16 a[20:23], v[164:167], a[144:147], a[20:23]
    v_perm_b32 v160, v22, v18, s74
    v_mfma_f32_16x16x32_bf16 a[52:55], v[164:167], a[148:151], a[52:55]
    v_perm_b32 v161, v30, v26, s74
    v_mfma_f32_16x16x32_bf16 a[84:87], v[164:167], a[152:155], a[84:87]
    v_perm_b32 v162, v38, v34, s74
    v_mfma_f32_16x16x32_bf16 a[116:119], v[164:167], a[156:159], a[116:119]
    v_perm_b32 v163, v46, v42, s74
    v_mfma_f32_16x16x32_bf16 a[24:27], v[168:171], a[144:147], a[24:27]
    v_perm_b32 v164, v22, v18, s75
    v_mfma_f32_16x16x32_bf16 a[56:59], v[168:171], a[148:151], a[56:59]
    v_perm_b32 v165, v30, v26, s75
    v_mfma_f32_16x16x32_bf16 a[88:91], v[168:171], a[152:155], a[88:91]
    v_perm_b32 v166, v38, v34, s75
    v_mfma_f32_16x16x32_bf16 a[120:123], v[168:171], a[156:159], a[120:123]
    v_perm_b32 v167, v46, v42, s75
    v_mfma_f32_16x16x32_bf16 a[28:31], v[172:175], a[144:147], a[28:31]
    v_perm_b32 v168, v23, v19, s74
    v_mfma_f32_16x16x32_bf16 a[60:63], v[172:175], a[148:151], a[60:63]
    v_perm_b32 v169, v31, v27, s74
    v_mfma_f32_16x16x32_bf16 a[92:95], v[172:175], a[152:155], a[92:95]
    v_perm_b32 v170, v39, v35, s74
    v_mfma_f32_16x16x32_bf16 a[124:127], v[172:175], a[156:159], a[124:127]
    v_perm_b32 v171, v47, v43, s74
    v_perm_b32 v172, v23, v19, s75
    v_perm_b32 v173, v31, v27, s75
    v_perm_b32 v174, v39, v35, s75
    v_perm_b32 v175, v47, v43, s75
    v_add_u32 v10, 0x100, v10
    v_add_u32 v11, 0x100, v11
    v_add_u32 v12, 0x100, v12
    v_add_u32 v13, 0x100, v13
    s_add_u32 s10, s10, 1
    s_cmp_eq_u32 s10, 4
    s_cbranch_scc1 attention
    s_cmp_eq_u32 s10, 8
    s_cbranch_scc1 epilogue
    s_cmp_eq_u32 s10, 7
    s_cbranch_scc1 it7
    s_cmp_gt_u32 s10, 4
    s_cbranch_scc1 gemm_loop
    s_cmp_eq_u32 s10, 2
    s_cbranch_scc1 it2
    s_cmp_eq_u32 s10, 3
    s_cbranch_scc1 it3
it1:
    buffer_load_dword v251, v250, s[56:59], s14 offen
    s_branch gemm_loop
it2:
    buffer_load_dwordx4 a[160:163], v14, s[44:47], s70 offen offset:0
    buffer_load_dwordx4 a[164:167], v14, s[44:47], s70 offen offset:16
    buffer_load_dwordx4 a[168:171], v14, s[44:47], s70 offen offset:32
    buffer_load_dwordx4 a[172:175], v14, s[44:47], s70 offen offset:48
    buffer_load_dwordx4 a[176:179], v14, s[44:47], s71 offen offset:0
    buffer_load_dwordx4 a[180:183], v14, s[44:47], s71 offen offset:16
    buffer_load_dwordx4 a[184:187], v14, s[44:47], s71 offen offset:32
    buffer_load_dwordx4 a[188:191], v14, s[44:47], s71 offen offset:48
    s_branch gemm_loop
it3:
    buffer_load_dwordx4 v[176:179], v15, s[48:51], s70 offen offset:0
    buffer_load_dwordx4 v[180:183], v15, s[48:51], s70 offen offset:256
    buffer_load_dwordx4 v[184:187], v15, s[48:51], s70 offen offset:512
    buffer_load_dwordx4 v[188:191], v15, s[48:51], s70 offen offset:768
    buffer_load_dwordx4 v[192:195], v15, s[48:51], s71 offen offset:0
    buffer_load_dwordx4 v[196:199], v15, s[48:51], s71 offen offset:256
    buffer_load_dwordx4 v[200:203], v15, s[48:51], s71 offen offset:512
    buffer_load_dwordx4 v[204:207], v15, s[48:51], s71 offen offset:768
    s_mov_b64 s[64:65], s[56:57]
    s_mov_b32 s68, s11
    s_mov_b32 s69, 0x8000
    v_and_b32 v245, 15, v1
    v_lshrrev_b32 v246, 4, v1
    v_lshlrev_b32 v247, 4, v245
    v_lshl_add_u32 v2, v246, 13, v247
    v_add_u32 v3, 0x400, v2
    v_add_u32 v4, 0x800, v2
    v_add_u32 v5, 0xc00, v2
    v_add_u32 v6, 0x1000, v2
    v_add_u32 v7, 0x1400, v2
    v_add_u32 v8, 0x1800, v2
    v_add_u32 v9, 0x1c00, v2
    s_branch gemm_loop
it7:
    s_mov_b32 s66, 0
    s_branch gemm_loop
attention:
    s_nop 9
    s_waitcnt lgkmcnt(0)
    s_waitcnt vmcnt(0)
    buffer_load_dwordx4 a[192:195], v14, s[44:47], s72 offen offset:0
    buffer_load_dwordx4 a[196:199], v14, s[44:47], s72 offen offset:16
    buffer_load_dwordx4 a[200:203], v14, s[44:47], s72 offen offset:32
    buffer_load_dwordx4 a[204:207], v14, s[44:47], s72 offen offset:48
    buffer_load_dwordx4 a[208:211], v14, s[44:47], s73 offen offset:0
    buffer_load_dwordx4 a[212:215], v14, s[44:47], s73 offen offset:16
    buffer_load_dwordx4 a[216:219], v14, s[44:47], s73 offen offset:32
    buffer_load_dwordx4 a[220:223], v14, s[44:47], s73 offen offset:48
    buffer_load_dwordx4 v[208:211], v15, s[48:51], s72 offen offset:0
    buffer_load_dwordx4 v[212:215], v15, s[48:51], s72 offen offset:256
    buffer_load_dwordx4 v[216:219], v15, s[48:51], s72 offen offset:512
    buffer_load_dwordx4 v[220:223], v15, s[48:51], s72 offen offset:768
    buffer_load_dwordx4 v[224:227], v15, s[48:51], s73 offen offset:0
    buffer_load_dwordx4 v[228:231], v15, s[48:51], s73 offen offset:256
    buffer_load_dwordx4 v[232:235], v15, s[48:51], s73 offen offset:512
    buffer_load_dwordx4 v[236:239], v15, s[48:51], s73 offen offset:768
    v_and_b32 v245, 15, v1
    v_lshrrev_b32 v246, 4, v1
    s_lshl_b32 s3, s7, 8
    s_add_u32 s3, s3, 0x10000
    v_lshl_add_u32 v248, v246, 2, 0
    v_xor_b32 v248, v248, v245
    v_lshlrev_b32 v248, 4, v248
    v_lshl_add_u32 v248, v245, 10, v248
    v_add_u32 v240, s3, v248
    v_lshl_add_u32 v248, v246, 2, 1
    v_xor_b32 v248, v248, v245
    v_lshlrev_b32 v248, 4, v248
    v_lshl_add_u32 v248, v245, 10, v248
    v_add_u32 v241, s3, v248
    v_lshl_add_u32 v248, v246, 2, 2
    v_xor_b32 v248, v248, v245
    v_lshlrev_b32 v248, 4, v248
    v_lshl_add_u32 v248, v245, 10, v248
    v_add_u32 v242, s3, v248
    v_lshl_add_u32 v248, v246, 2, 3
    v_xor_b32 v248, v248, v245
    v_lshlrev_b32 v248, 4, v248
    v_lshl_add_u32 v248, v245, 10, v248
    v_add_u32 v243, s3, v248
    v_add_u32 v10, 0xfc00, v10
    v_add_u32 v11, 0xfc00, v11
    v_add_u32 v12, 0xfc00, v12
    v_add_u32 v13, 0xfc00, v13
    v_accvgpr_read_b32 v245, a0
    v_accvgpr_read_b32 v246, a4
    v_accvgpr_read_b32 v247, a8
    v_accvgpr_read_b32 v248, a12
    v_accvgpr_read_b32 v249, a16
    v_accvgpr_read_b32 v250, a20
    v_accvgpr_read_b32 v251, a24
    v_accvgpr_read_b32 v252, a28
    v_cvt_pk_bf16_f32 v144, v245, v246
    v_cvt_pk_bf16_f32 v145, v247, v248
    v_cvt_pk_bf16_f32 v146, v249, v250
    v_cvt_pk_bf16_f32 v147, v251, v252
    v_accvgpr_read_b32 v245, a1
    v_accvgpr_read_b32 v246, a5
    v_accvgpr_read_b32 v247, a9
    v_accvgpr_read_b32 v248, a13
    v_accvgpr_read_b32 v249, a17
    v_accvgpr_read_b32 v250, a21
    v_accvgpr_read_b32 v251, a25
    v_accvgpr_read_b32 v252, a29
    v_cvt_pk_bf16_f32 v148, v245, v246
    v_cvt_pk_bf16_f32 v149, v247, v248
    v_cvt_pk_bf16_f32 v150, v249, v250
    v_cvt_pk_bf16_f32 v151, v251, v252
    v_accvgpr_read_b32 v245, a2
    v_accvgpr_read_b32 v246, a6
    v_accvgpr_read_b32 v247, a10
    v_accvgpr_read_b32 v248, a14
    v_accvgpr_read_b32 v249, a18
    v_accvgpr_read_b32 v250, a22
    v_accvgpr_read_b32 v251, a26
    v_accvgpr_read_b32 v252, a30
    v_cvt_pk_bf16_f32 v152, v245, v246
    v_cvt_pk_bf16_f32 v153, v247, v248
    v_cvt_pk_bf16_f32 v154, v249, v250
    v_cvt_pk_bf16_f32 v155, v251, v252
    v_accvgpr_read_b32 v245, a3
    v_accvgpr_read_b32 v246, a7
    v_accvgpr_read_b32 v247, a11
    v_accvgpr_read_b32 v248, a15
    v_accvgpr_read_b32 v249, a19
    v_accvgpr_read_b32 v250, a23
    v_accvgpr_read_b32 v251, a27
    v_accvgpr_read_b32 v252, a31
    v_cvt_pk_bf16_f32 v156, v245, v246
    v_cvt_pk_bf16_f32 v157, v247, v248
    v_cvt_pk_bf16_f32 v158, v249, v250
    v_cvt_pk_bf16_f32 v159, v251, v252
    v_accvgpr_read_b32 v245, a32
    v_accvgpr_read_b32 v246, a36
    v_accvgpr_read_b32 v247, a40
    v_accvgpr_read_b32 v248, a44
    v_accvgpr_read_b32 v249, a48
    v_accvgpr_read_b32 v250, a52
    v_accvgpr_read_b32 v251, a56
    v_accvgpr_read_b32 v252, a60
    v_cvt_pk_bf16_f32 v160, v245, v246
    v_cvt_pk_bf16_f32 v161, v247, v248
    v_cvt_pk_bf16_f32 v162, v249, v250
    v_cvt_pk_bf16_f32 v163, v251, v252
    v_accvgpr_read_b32 v245, a33
    v_accvgpr_read_b32 v246, a37
    v_accvgpr_read_b32 v247, a41
    v_accvgpr_read_b32 v248, a45
    v_accvgpr_read_b32 v249, a49
    v_accvgpr_read_b32 v250, a53
    v_accvgpr_read_b32 v251, a57
    v_accvgpr_read_b32 v252, a61
    v_cvt_pk_bf16_f32 v164, v245, v246
    v_cvt_pk_bf16_f32 v165, v247, v248
    v_cvt_pk_bf16_f32 v166, v249, v250
    v_cvt_pk_bf16_f32 v167, v251, v252
    v_accvgpr_read_b32 v245, a34
    v_accvgpr_read_b32 v246, a38
    v_accvgpr_read_b32 v247, a42
    v_accvgpr_read_b32 v248, a46
    v_accvgpr_read_b32 v249, a50
    v_accvgpr_read_b32 v250, a54
    v_accvgpr_read_b32 v251, a58
    v_accvgpr_read_b32 v252, a62
    v_cvt_pk_bf16_f32 v168, v245, v246
    v_cvt_pk_bf16_f32 v169, v247, v248
    v_cvt_pk_bf16_f32 v170, v249, v250
    v_cvt_pk_bf16_f32 v171, v251, v252
    v_accvgpr_read_b32 v245, a35
    v_accvgpr_read_b32 v246, a39
    v_accvgpr_read_b32 v247, a43
    v_accvgpr_read_b32 v248, a47
    v_accvgpr_read_b32 v249, a51
    v_accvgpr_read_b32 v250, a55
    v_accvgpr_read_b32 v251, a59
    v_accvgpr_read_b32 v252, a63
    v_cvt_pk_bf16_f32 v172, v245, v246
    v_cvt_pk_bf16_f32 v173, v247, v248
    v_cvt_pk_bf16_f32 v174, v249, v250
    v_cvt_pk_bf16_f32 v175, v251, v252
    v_mfma_f32_16x16x32_bf16 v[80:83], a[160:163], v[144:147], 0
    v_mfma_f32_16x16x32_bf16 v[88:91], a[160:163], v[160:163], 0
    v_mfma_f32_16x16x32_bf16 v[84:87], a[176:179], v[144:147], 0
    v_mfma_f32_16x16x32_bf16 v[92:95], a[176:179], v[160:163], 0
    v_mfma_f32_16x16x32_bf16 v[80:83], a[164:167], v[148:151], v[80:83]
    v_mfma_f32_16x16x32_bf16 v[88:91], a[164:167], v[164:167], v[88:91]
    v_mfma_f32_16x16x32_bf16 v[84:87], a[180:183], v[148:151], v[84:87]
    v_mfma_f32_16x16x32_bf16 v[92:95], a[180:183], v[164:167], v[92:95]
    v_mfma_f32_16x16x32_bf16 v[80:83], a[168:171], v[152:155], v[80:83]
    v_mfma_f32_16x16x32_bf16 v[88:91], a[168:171], v[168:171], v[88:91]
    v_mfma_f32_16x16x32_bf16 v[84:87], a[184:187], v[152:155], v[84:87]
    v_mfma_f32_16x16x32_bf16 v[92:95], a[184:187], v[168:171], v[92:95]
    v_mfma_f32_16x16x32_bf16 v[80:83], a[172:175], v[156:159], v[80:83]
    v_mfma_f32_16x16x32_bf16 v[88:91], a[172:175], v[172:175], v[88:91]
    v_mfma_f32_16x16x32_bf16 v[84:87], a[188:191], v[156:159], v[84:87]
    v_mfma_f32_16x16x32_bf16 v[92:95], a[188:191], v[172:175], v[92:95]
    v_perm_b32 v144, v180, v176, s74
    v_perm_b32 v145, v188, v184, s74
    v_perm_b32 v146, v196, v192, s74
    v_perm_b32 v147, v204, v200, s74
    v_perm_b32 v148, v180, v176, s75
    v_perm_b32 v149, v188, v184, s75
    v_perm_b32 v150, v196, v192, s75
    v_perm_b32 v151, v204, v200, s75
    v_perm_b32 v152, v181, v177, s74
    v_perm_b32 v153, v189, v185, s74
    v_perm_b32 v154, v197, v193, s74
    v_perm_b32 v155, v205, v201, s74
    v_perm_b32 v156, v181, v177, s75
    v_perm_b32 v157, v189, v185, s75
    v_perm_b32 v158, v197, v193, s75
    v_perm_b32 v159, v205, v201, s75
    v_perm_b32 v160, v182, v178, s74
    v_perm_b32 v161, v190, v186, s74
    v_perm_b32 v162, v198, v194, s74
    v_perm_b32 v163, v206, v202, s74
    v_perm_b32 v164, v182, v178, s75
    v_perm_b32 v165, v190, v186, s75
    v_perm_b32 v166, v198, v194, s75
    v_perm_b32 v167, v206, v202, s75
    v_perm_b32 v168, v183, v179, s74
    v_perm_b32 v169, v191, v187, s74
    v_perm_b32 v170, v199, v195, s74
    v_perm_b32 v171, v207, v203, s74
    v_perm_b32 v172, v183, v179, s75
    v_perm_b32 v173, v191, v187, s75
    v_perm_b32 v174, v199, v195, s75
    v_perm_b32 v175, v207, v203, s75
    v_cvt_pk_bf16_f32 v200, v80, v81
    v_cvt_pk_bf16_f32 v204, v88, v89
    v_cvt_pk_bf16_f32 v201, v82, v83
    v_cvt_pk_bf16_f32 v205, v90, v91
    v_cvt_pk_bf16_f32 v202, v84, v85
    v_cvt_pk_bf16_f32 v206, v92, v93
    v_cvt_pk_bf16_f32 v203, v86, v87
    v_cvt_pk_bf16_f32 v207, v94, v95
    v_lshlrev_b32 v80, 16, v200
    v_lshlrev_b32 v88, 16, v204
    v_and_b32 v81, s79, v200
    v_and_b32 v89, s79, v204
    v_lshlrev_b32 v82, 16, v201
    v_lshlrev_b32 v90, 16, v205
    v_and_b32 v83, s79, v201
    v_and_b32 v91, s79, v205
    v_lshlrev_b32 v84, 16, v202
    v_lshlrev_b32 v92, 16, v206
    v_and_b32 v85, s79, v202
    v_and_b32 v93, s79, v206
    v_lshlrev_b32 v86, 16, v203
    v_lshlrev_b32 v94, 16, v207
    v_and_b32 v87, s79, v203
    v_and_b32 v95, s79, v207
    v_mul_f32 v80, s77, v80
    v_mul_f32 v88, s77, v88
    v_mul_f32 v81, s77, v81
    v_mul_f32 v89, s77, v89
    v_mul_f32 v82, s77, v82
    v_mul_f32 v90, s77, v90
    v_mul_f32 v83, s77, v83
    v_mul_f32 v91, s77, v91
    v_mul_f32 v84, s77, v84
    v_mul_f32 v92, s77, v92
    v_mul_f32 v85, s77, v85
    v_mul_f32 v93, s77, v93
    v_mul_f32 v86, s77, v86
    v_mul_f32 v94, s77, v94
    v_mul_f32 v87, s77, v87
    v_mul_f32 v95, s77, v95
    v_cvt_pk_bf16_f32 v200, v80, v81
    v_cvt_pk_bf16_f32 v204, v88, v89
    v_cvt_pk_bf16_f32 v201, v82, v83
    v_cvt_pk_bf16_f32 v205, v90, v91
    v_cvt_pk_bf16_f32 v202, v84, v85
    v_cvt_pk_bf16_f32 v206, v92, v93
    v_cvt_pk_bf16_f32 v203, v86, v87
    v_cvt_pk_bf16_f32 v207, v94, v95
    v_lshlrev_b32 v80, 16, v200
    v_lshlrev_b32 v88, 16, v204
    v_and_b32 v81, s79, v200
    v_and_b32 v89, s79, v204
    v_lshlrev_b32 v82, 16, v201
    v_lshlrev_b32 v90, 16, v205
    v_and_b32 v83, s79, v201
    v_and_b32 v91, s79, v205
    v_lshlrev_b32 v84, 16, v202
    v_lshlrev_b32 v92, 16, v206
    v_and_b32 v85, s79, v202
    v_and_b32 v93, s79, v206
    v_lshlrev_b32 v86, 16, v203
    v_lshlrev_b32 v94, 16, v207
    v_and_b32 v87, s79, v203
    v_and_b32 v95, s79, v207
    v_max3_f32 v200, v80, v81, v82
    v_max3_f32 v204, v88, v89, v90
    v_max3_f32 v201, v83, v84, v85
    v_max3_f32 v205, v91, v92, v93
    v_max3_f32 v200, v200, v86, v87
    v_max3_f32 v204, v204, v94, v95
    v_max_f32 v200, v200, v201
    v_max_f32 v204, v204, v205
    v_mov_b32 v201, v200
    v_mov_b32 v205, v204
    s_nop 0
    v_permlane16_swap_b32 v200, v201
    v_permlane16_swap_b32 v204, v205
    v_max_f32 v200, v200, v201
    v_max_f32 v204, v204, v205
    v_mov_b32 v201, v200
    v_mov_b32 v205, v204
    s_nop 0
    v_permlane32_swap_b32 v200, v201
    v_permlane32_swap_b32 v204, v205
    v_max_f32 v200, v200, v201
    v_max_f32 v204, v204, v205
    v_sub_f32 v80, v80, v200
    v_sub_f32 v88, v88, v204
    v_sub_f32 v81, v81, v200
    v_sub_f32 v89, v89, v204
    v_sub_f32 v82, v82, v200
    v_sub_f32 v90, v90, v204
    v_sub_f32 v83, v83, v200
    v_sub_f32 v91, v91, v204
    v_sub_f32 v84, v84, v200
    v_sub_f32 v92, v92, v204
    v_sub_f32 v85, v85, v200
    v_sub_f32 v93, v93, v204
    v_sub_f32 v86, v86, v200
    v_sub_f32 v94, v94, v204
    v_sub_f32 v87, v87, v200
    v_sub_f32 v95, v95, v204
    v_mul_f32 v80, s78, v80
    v_mul_f32 v88, s78, v88
    v_mul_f32 v81, s78, v81
    v_mul_f32 v89, s78, v89
    v_mul_f32 v82, s78, v82
    v_mul_f32 v90, s78, v90
    v_mul_f32 v83, s78, v83
    v_mul_f32 v91, s78, v91
    v_mul_f32 v84, s78, v84
    v_mul_f32 v92, s78, v92
    v_mul_f32 v85, s78, v85
    v_mul_f32 v93, s78, v93
    v_mul_f32 v86, s78, v86
    v_mul_f32 v94, s78, v94
    v_mul_f32 v87, s78, v87
    v_mul_f32 v95, s78, v95
    v_exp_f32 v80, v80
    v_exp_f32 v88, v88
    v_exp_f32 v81, v81
    v_exp_f32 v89, v89
    v_exp_f32 v82, v82
    v_exp_f32 v90, v90
    v_exp_f32 v83, v83
    v_exp_f32 v91, v91
    v_exp_f32 v84, v84
    v_exp_f32 v92, v92
    v_exp_f32 v85, v85
    v_exp_f32 v93, v93
    v_exp_f32 v86, v86
    v_exp_f32 v94, v94
    v_exp_f32 v87, v87
    v_exp_f32 v95, v95
    v_add_f32 v200, v80, v81
    v_add_f32 v204, v88, v89
    v_add_f32 v201, v82, v83
    v_add_f32 v205, v90, v91
    v_add_f32 v202, v84, v85
    v_add_f32 v206, v92, v93
    v_add_f32 v203, v86, v87
    v_add_f32 v207, v94, v95
    v_add_f32 v200, v200, v201
    v_add_f32 v204, v204, v205
    v_add_f32 v202, v202, v203
    v_add_f32 v206, v206, v207
    v_add_f32 v200, v200, v202
    v_add_f32 v204, v204, v206
    v_mov_b32 v201, v200
    v_mov_b32 v205, v204
    s_nop 0
    v_permlane16_swap_b32 v200, v201
    v_permlane16_swap_b32 v204, v205
    v_add_f32 v200, v200, v201
    v_add_f32 v204, v204, v205
    v_mov_b32 v201, v200
    v_mov_b32 v205, v204
    s_nop 0
    v_permlane32_swap_b32 v200, v201
    v_permlane32_swap_b32 v204, v205
    v_add_f32 v200, v200, v201
    v_add_f32 v204, v204, v205
    v_rcp_f32 v200, v200
    v_rcp_f32 v204, v204
    v_mul_f32 v80, v80, v200
    v_mul_f32 v88, v88, v204
    v_mul_f32 v81, v81, v200
    v_mul_f32 v89, v89, v204
    v_mul_f32 v82, v82, v200
    v_mul_f32 v90, v90, v204
    v_mul_f32 v83, v83, v200
    v_mul_f32 v91, v91, v204
    v_mul_f32 v84, v84, v200
    v_mul_f32 v92, v92, v204
    v_mul_f32 v85, v85, v200
    v_mul_f32 v93, v93, v204
    v_mul_f32 v86, v86, v200
    v_mul_f32 v94, v94, v204
    v_mul_f32 v87, v87, v200
    v_mul_f32 v95, v95, v204
    v_cvt_pk_bf16_f32 v192, v80, v81
    v_cvt_pk_bf16_f32 v196, v88, v89
    v_cvt_pk_bf16_f32 v193, v82, v83
    v_cvt_pk_bf16_f32 v197, v90, v91
    v_cvt_pk_bf16_f32 v194, v84, v85
    v_cvt_pk_bf16_f32 v198, v92, v93
    v_cvt_pk_bf16_f32 v195, v86, v87
    v_cvt_pk_bf16_f32 v199, v94, v95
    s_nop 0
    v_mfma_f32_16x16x32_bf16 v[80:83], v[144:147], v[192:195], 0
    v_mfma_f32_16x16x32_bf16 v[84:87], v[148:151], v[192:195], 0
    v_mfma_f32_16x16x32_bf16 v[88:91], v[152:155], v[192:195], 0
    v_mfma_f32_16x16x32_bf16 v[92:95], v[156:159], v[192:195], 0
    v_mfma_f32_16x16x32_bf16 v[96:99], v[160:163], v[192:195], 0
    v_mfma_f32_16x16x32_bf16 v[100:103], v[164:167], v[192:195], 0
    v_mfma_f32_16x16x32_bf16 v[104:107], v[168:171], v[192:195], 0
    v_mfma_f32_16x16x32_bf16 v[108:111], v[172:175], v[192:195], 0
    v_mfma_f32_16x16x32_bf16 v[112:115], v[144:147], v[196:199], 0
    v_mfma_f32_16x16x32_bf16 v[116:119], v[148:151], v[196:199], 0
    v_mfma_f32_16x16x32_bf16 v[120:123], v[152:155], v[196:199], 0
    v_mfma_f32_16x16x32_bf16 v[124:127], v[156:159], v[196:199], 0
    v_mfma_f32_16x16x32_bf16 v[128:131], v[160:163], v[196:199], 0
    v_mfma_f32_16x16x32_bf16 v[132:135], v[164:167], v[196:199], 0
    v_mfma_f32_16x16x32_bf16 v[136:139], v[168:171], v[196:199], 0
    v_mfma_f32_16x16x32_bf16 v[140:143], v[172:175], v[196:199], 0
    v_cvt_pk_bf16_f32 v176, v80, v84
    v_cvt_pk_bf16_f32 v177, v88, v92
    v_cvt_pk_bf16_f32 v178, v96, v100
    v_cvt_pk_bf16_f32 v179, v104, v108
    ds_write_b128 v240, v[176:179] offset:0
    v_cvt_pk_bf16_f32 v180, v81, v85
    v_cvt_pk_bf16_f32 v181, v89, v93
    v_cvt_pk_bf16_f32 v182, v97, v101
    v_cvt_pk_bf16_f32 v183, v105, v109
    ds_write_b128 v241, v[180:183] offset:0
    v_cvt_pk_bf16_f32 v184, v82, v86
    v_cvt_pk_bf16_f32 v185, v90, v94
    v_cvt_pk_bf16_f32 v186, v98, v102
    v_cvt_pk_bf16_f32 v187, v106, v110
    ds_write_b128 v242, v[184:187] offset:0
    v_cvt_pk_bf16_f32 v188, v83, v87
    v_cvt_pk_bf16_f32 v189, v91, v95
    v_cvt_pk_bf16_f32 v190, v99, v103
    v_cvt_pk_bf16_f32 v191, v107, v111
    ds_write_b128 v243, v[188:191] offset:0
    v_cvt_pk_bf16_f32 v176, v112, v116
    v_cvt_pk_bf16_f32 v177, v120, v124
    v_cvt_pk_bf16_f32 v178, v128, v132
    v_cvt_pk_bf16_f32 v179, v136, v140
    ds_write_b128 v240, v[176:179] offset:16384
    v_cvt_pk_bf16_f32 v180, v113, v117
    v_cvt_pk_bf16_f32 v181, v121, v125
    v_cvt_pk_bf16_f32 v182, v129, v133
    v_cvt_pk_bf16_f32 v183, v137, v141
    ds_write_b128 v241, v[180:183] offset:16384
    v_cvt_pk_bf16_f32 v184, v114, v118
    v_cvt_pk_bf16_f32 v185, v122, v126
    v_cvt_pk_bf16_f32 v186, v130, v134
    v_cvt_pk_bf16_f32 v187, v138, v142
    ds_write_b128 v242, v[184:187] offset:16384
    v_cvt_pk_bf16_f32 v188, v115, v119
    v_cvt_pk_bf16_f32 v189, v123, v127
    v_cvt_pk_bf16_f32 v190, v131, v135
    v_cvt_pk_bf16_f32 v191, v139, v143
    ds_write_b128 v243, v[188:191] offset:16384
    v_accvgpr_read_b32 v245, a64
    v_accvgpr_read_b32 v246, a68
    v_accvgpr_read_b32 v247, a72
    v_accvgpr_read_b32 v248, a76
    v_accvgpr_read_b32 v249, a80
    v_accvgpr_read_b32 v250, a84
    v_accvgpr_read_b32 v251, a88
    v_accvgpr_read_b32 v252, a92
    v_cvt_pk_bf16_f32 v144, v245, v246
    v_cvt_pk_bf16_f32 v145, v247, v248
    v_cvt_pk_bf16_f32 v146, v249, v250
    v_cvt_pk_bf16_f32 v147, v251, v252
    v_accvgpr_read_b32 v245, a65
    v_accvgpr_read_b32 v246, a69
    v_accvgpr_read_b32 v247, a73
    v_accvgpr_read_b32 v248, a77
    v_accvgpr_read_b32 v249, a81
    v_accvgpr_read_b32 v250, a85
    v_accvgpr_read_b32 v251, a89
    v_accvgpr_read_b32 v252, a93
    v_cvt_pk_bf16_f32 v148, v245, v246
    v_cvt_pk_bf16_f32 v149, v247, v248
    v_cvt_pk_bf16_f32 v150, v249, v250
    v_cvt_pk_bf16_f32 v151, v251, v252
    v_accvgpr_read_b32 v245, a66
    v_accvgpr_read_b32 v246, a70
    v_accvgpr_read_b32 v247, a74
    v_accvgpr_read_b32 v248, a78
    v_accvgpr_read_b32 v249, a82
    v_accvgpr_read_b32 v250, a86
    v_accvgpr_read_b32 v251, a90
    v_accvgpr_read_b32 v252, a94
    v_cvt_pk_bf16_f32 v152, v245, v246
    v_cvt_pk_bf16_f32 v153, v247, v248
    v_cvt_pk_bf16_f32 v154, v249, v250
    v_cvt_pk_bf16_f32 v155, v251, v252
    v_accvgpr_read_b32 v245, a67
    v_accvgpr_read_b32 v246, a71
    v_accvgpr_read_b32 v247, a75
    v_accvgpr_read_b32 v248, a79
    v_accvgpr_read_b32 v249, a83
    v_accvgpr_read_b32 v250, a87
    v_accvgpr_read_b32 v251, a91
    v_accvgpr_read_b32 v252, a95
    v_cvt_pk_bf16_f32 v156, v245, v246
    v_cvt_pk_bf16_f32 v157, v247, v248
    v_cvt_pk_bf16_f32 v158, v249, v250
    v_cvt_pk_bf16_f32 v159, v251, v252
    v_accvgpr_read_b32 v245, a96
    v_accvgpr_read_b32 v246, a100
    v_accvgpr_read_b32 v247, a104
    v_accvgpr_read_b32 v248, a108
    v_accvgpr_read_b32 v249, a112
    v_accvgpr_read_b32 v250, a116
    v_accvgpr_read_b32 v251, a120
    v_accvgpr_read_b32 v252, a124
    v_cvt_pk_bf16_f32 v160, v245, v246
    v_cvt_pk_bf16_f32 v161, v247, v248
    v_cvt_pk_bf16_f32 v162, v249, v250
    v_cvt_pk_bf16_f32 v163, v251, v252
    v_accvgpr_read_b32 v245, a97
    v_accvgpr_read_b32 v246, a101
    v_accvgpr_read_b32 v247, a105
    v_accvgpr_read_b32 v248, a109
    v_accvgpr_read_b32 v249, a113
    v_accvgpr_read_b32 v250, a117
    v_accvgpr_read_b32 v251, a121
    v_accvgpr_read_b32 v252, a125
    v_cvt_pk_bf16_f32 v164, v245, v246
    v_cvt_pk_bf16_f32 v165, v247, v248
    v_cvt_pk_bf16_f32 v166, v249, v250
    v_cvt_pk_bf16_f32 v167, v251, v252
    v_accvgpr_read_b32 v245, a98
    v_accvgpr_read_b32 v246, a102
    v_accvgpr_read_b32 v247, a106
    v_accvgpr_read_b32 v248, a110
    v_accvgpr_read_b32 v249, a114
    v_accvgpr_read_b32 v250, a118
    v_accvgpr_read_b32 v251, a122
    v_accvgpr_read_b32 v252, a126
    v_cvt_pk_bf16_f32 v168, v245, v246
    v_cvt_pk_bf16_f32 v169, v247, v248
    v_cvt_pk_bf16_f32 v170, v249, v250
    v_cvt_pk_bf16_f32 v171, v251, v252
    v_accvgpr_read_b32 v245, a99
    v_accvgpr_read_b32 v246, a103
    v_accvgpr_read_b32 v247, a107
    v_accvgpr_read_b32 v248, a111
    v_accvgpr_read_b32 v249, a115
    v_accvgpr_read_b32 v250, a119
    v_accvgpr_read_b32 v251, a123
    v_accvgpr_read_b32 v252, a127
    v_cvt_pk_bf16_f32 v172, v245, v246
    v_cvt_pk_bf16_f32 v173, v247, v248
    v_cvt_pk_bf16_f32 v174, v249, v250
    v_cvt_pk_bf16_f32 v175, v251, v252
    s_waitcnt vmcnt(8)
    v_mfma_f32_16x16x32_bf16 v[80:83], a[192:195], v[144:147], 0
    v_mfma_f32_16x16x32_bf16 v[88:91], a[192:195], v[160:163], 0
    v_mfma_f32_16x16x32_bf16 v[84:87], a[208:211], v[144:147], 0
    v_mfma_f32_16x16x32_bf16 v[92:95], a[208:211], v[160:163], 0
    v_mfma_f32_16x16x32_bf16 v[80:83], a[196:199], v[148:151], v[80:83]
    v_mfma_f32_16x16x32_bf16 v[88:91], a[196:199], v[164:167], v[88:91]
    v_mfma_f32_16x16x32_bf16 v[84:87], a[212:215], v[148:151], v[84:87]
    v_mfma_f32_16x16x32_bf16 v[92:95], a[212:215], v[164:167], v[92:95]
    v_mfma_f32_16x16x32_bf16 v[80:83], a[200:203], v[152:155], v[80:83]
    v_mfma_f32_16x16x32_bf16 v[88:91], a[200:203], v[168:171], v[88:91]
    v_mfma_f32_16x16x32_bf16 v[84:87], a[216:219], v[152:155], v[84:87]
    v_mfma_f32_16x16x32_bf16 v[92:95], a[216:219], v[168:171], v[92:95]
    v_mfma_f32_16x16x32_bf16 v[80:83], a[204:207], v[156:159], v[80:83]
    v_mfma_f32_16x16x32_bf16 v[88:91], a[204:207], v[172:175], v[88:91]
    v_mfma_f32_16x16x32_bf16 v[84:87], a[220:223], v[156:159], v[84:87]
    v_mfma_f32_16x16x32_bf16 v[92:95], a[220:223], v[172:175], v[92:95]
    s_waitcnt vmcnt(0)
    v_perm_b32 v144, v212, v208, s74
    v_perm_b32 v145, v220, v216, s74
    v_perm_b32 v146, v228, v224, s74
    v_perm_b32 v147, v236, v232, s74
    v_perm_b32 v148, v212, v208, s75
    v_perm_b32 v149, v220, v216, s75
    v_perm_b32 v150, v228, v224, s75
    v_perm_b32 v151, v236, v232, s75
    v_perm_b32 v152, v213, v209, s74
    v_perm_b32 v153, v221, v217, s74
    v_perm_b32 v154, v229, v225, s74
    v_perm_b32 v155, v237, v233, s74
    v_perm_b32 v156, v213, v209, s75
    v_perm_b32 v157, v221, v217, s75
    v_perm_b32 v158, v229, v225, s75
    v_perm_b32 v159, v237, v233, s75
    v_perm_b32 v160, v214, v210, s74
    v_perm_b32 v161, v222, v218, s74
    v_perm_b32 v162, v230, v226, s74
    v_perm_b32 v163, v238, v234, s74
    v_perm_b32 v164, v214, v210, s75
    v_perm_b32 v165, v222, v218, s75
    v_perm_b32 v166, v230, v226, s75
    v_perm_b32 v167, v238, v234, s75
    v_perm_b32 v168, v215, v211, s74
    v_perm_b32 v169, v223, v219, s74
    v_perm_b32 v170, v231, v227, s74
    v_perm_b32 v171, v239, v235, s74
    v_perm_b32 v172, v215, v211, s75
    v_perm_b32 v173, v223, v219, s75
    v_perm_b32 v174, v231, v227, s75
    v_perm_b32 v175, v239, v235, s75
    v_cvt_pk_bf16_f32 v232, v80, v81
    v_cvt_pk_bf16_f32 v236, v88, v89
    v_cvt_pk_bf16_f32 v233, v82, v83
    v_cvt_pk_bf16_f32 v237, v90, v91
    v_cvt_pk_bf16_f32 v234, v84, v85
    v_cvt_pk_bf16_f32 v238, v92, v93
    v_cvt_pk_bf16_f32 v235, v86, v87
    v_cvt_pk_bf16_f32 v239, v94, v95
    v_lshlrev_b32 v80, 16, v232
    v_lshlrev_b32 v88, 16, v236
    v_and_b32 v81, s79, v232
    v_and_b32 v89, s79, v236
    v_lshlrev_b32 v82, 16, v233
    v_lshlrev_b32 v90, 16, v237
    v_and_b32 v83, s79, v233
    v_and_b32 v91, s79, v237
    v_lshlrev_b32 v84, 16, v234
    v_lshlrev_b32 v92, 16, v238
    v_and_b32 v85, s79, v234
    v_and_b32 v93, s79, v238
    v_lshlrev_b32 v86, 16, v235
    v_lshlrev_b32 v94, 16, v239
    v_and_b32 v87, s79, v235
    v_and_b32 v95, s79, v239
    v_mul_f32 v80, s77, v80
    v_mul_f32 v88, s77, v88
    v_mul_f32 v81, s77, v81
    v_mul_f32 v89, s77, v89
    v_mul_f32 v82, s77, v82
    v_mul_f32 v90, s77, v90
    v_mul_f32 v83, s77, v83
    v_mul_f32 v91, s77, v91
    v_mul_f32 v84, s77, v84
    v_mul_f32 v92, s77, v92
    v_mul_f32 v85, s77, v85
    v_mul_f32 v93, s77, v93
    v_mul_f32 v86, s77, v86
    v_mul_f32 v94, s77, v94
    v_mul_f32 v87, s77, v87
    v_mul_f32 v95, s77, v95
    v_cvt_pk_bf16_f32 v232, v80, v81
    v_cvt_pk_bf16_f32 v236, v88, v89
    v_cvt_pk_bf16_f32 v233, v82, v83
    v_cvt_pk_bf16_f32 v237, v90, v91
    v_cvt_pk_bf16_f32 v234, v84, v85
    v_cvt_pk_bf16_f32 v238, v92, v93
    v_cvt_pk_bf16_f32 v235, v86, v87
    v_cvt_pk_bf16_f32 v239, v94, v95
    v_lshlrev_b32 v80, 16, v232
    v_lshlrev_b32 v88, 16, v236
    v_and_b32 v81, s79, v232
    v_and_b32 v89, s79, v236
    v_lshlrev_b32 v82, 16, v233
    v_lshlrev_b32 v90, 16, v237
    v_and_b32 v83, s79, v233
    v_and_b32 v91, s79, v237
    v_lshlrev_b32 v84, 16, v234
    v_lshlrev_b32 v92, 16, v238
    v_and_b32 v85, s79, v234
    v_and_b32 v93, s79, v238
    v_lshlrev_b32 v86, 16, v235
    v_lshlrev_b32 v94, 16, v239
    v_and_b32 v87, s79, v235
    v_and_b32 v95, s79, v239
    v_max3_f32 v232, v80, v81, v82
    v_max3_f32 v236, v88, v89, v90
    v_max3_f32 v233, v83, v84, v85
    v_max3_f32 v237, v91, v92, v93
    v_max3_f32 v232, v232, v86, v87
    v_max3_f32 v236, v236, v94, v95
    v_max_f32 v232, v232, v233
    v_max_f32 v236, v236, v237
    v_mov_b32 v233, v232
    v_mov_b32 v237, v236
    s_nop 0
    v_permlane16_swap_b32 v232, v233
    v_permlane16_swap_b32 v236, v237
    v_max_f32 v232, v232, v233
    v_max_f32 v236, v236, v237
    v_mov_b32 v233, v232
    v_mov_b32 v237, v236
    s_nop 0
    v_permlane32_swap_b32 v232, v233
    v_permlane32_swap_b32 v236, v237
    v_max_f32 v232, v232, v233
    v_max_f32 v236, v236, v237
    v_sub_f32 v80, v80, v232
    v_sub_f32 v88, v88, v236
    v_sub_f32 v81, v81, v232
    v_sub_f32 v89, v89, v236
    v_sub_f32 v82, v82, v232
    v_sub_f32 v90, v90, v236
    v_sub_f32 v83, v83, v232
    v_sub_f32 v91, v91, v236
    v_sub_f32 v84, v84, v232
    v_sub_f32 v92, v92, v236
    v_sub_f32 v85, v85, v232
    v_sub_f32 v93, v93, v236
    v_sub_f32 v86, v86, v232
    v_sub_f32 v94, v94, v236
    v_sub_f32 v87, v87, v232
    v_sub_f32 v95, v95, v236
    v_mul_f32 v80, s78, v80
    v_mul_f32 v88, s78, v88
    v_mul_f32 v81, s78, v81
    v_mul_f32 v89, s78, v89
    v_mul_f32 v82, s78, v82
    v_mul_f32 v90, s78, v90
    v_mul_f32 v83, s78, v83
    v_mul_f32 v91, s78, v91
    v_mul_f32 v84, s78, v84
    v_mul_f32 v92, s78, v92
    v_mul_f32 v85, s78, v85
    v_mul_f32 v93, s78, v93
    v_mul_f32 v86, s78, v86
    v_mul_f32 v94, s78, v94
    v_mul_f32 v87, s78, v87
    v_mul_f32 v95, s78, v95
    v_exp_f32 v80, v80
    v_exp_f32 v88, v88
    v_exp_f32 v81, v81
    v_exp_f32 v89, v89
    v_exp_f32 v82, v82
    v_exp_f32 v90, v90
    v_exp_f32 v83, v83
    v_exp_f32 v91, v91
    v_exp_f32 v84, v84
    v_exp_f32 v92, v92
    v_exp_f32 v85, v85
    v_exp_f32 v93, v93
    v_exp_f32 v86, v86
    v_exp_f32 v94, v94
    v_exp_f32 v87, v87
    v_exp_f32 v95, v95
    v_add_f32 v232, v80, v81
    v_add_f32 v236, v88, v89
    v_add_f32 v233, v82, v83
    v_add_f32 v237, v90, v91
    v_add_f32 v234, v84, v85
    v_add_f32 v238, v92, v93
    v_add_f32 v235, v86, v87
    v_add_f32 v239, v94, v95
    v_add_f32 v232, v232, v233
    v_add_f32 v236, v236, v237
    v_add_f32 v234, v234, v235
    v_add_f32 v238, v238, v239
    v_add_f32 v232, v232, v234
    v_add_f32 v236, v236, v238
    v_mov_b32 v233, v232
    v_mov_b32 v237, v236
    s_nop 0
    v_permlane16_swap_b32 v232, v233
    v_permlane16_swap_b32 v236, v237
    v_add_f32 v232, v232, v233
    v_add_f32 v236, v236, v237
    v_mov_b32 v233, v232
    v_mov_b32 v237, v236
    s_nop 0
    v_permlane32_swap_b32 v232, v233
    v_permlane32_swap_b32 v236, v237
    v_add_f32 v232, v232, v233
    v_add_f32 v236, v236, v237
    v_rcp_f32 v232, v232
    v_rcp_f32 v236, v236
    v_mul_f32 v80, v80, v232
    v_mul_f32 v88, v88, v236
    v_mul_f32 v81, v81, v232
    v_mul_f32 v89, v89, v236
    v_mul_f32 v82, v82, v232
    v_mul_f32 v90, v90, v236
    v_mul_f32 v83, v83, v232
    v_mul_f32 v91, v91, v236
    v_mul_f32 v84, v84, v232
    v_mul_f32 v92, v92, v236
    v_mul_f32 v85, v85, v232
    v_mul_f32 v93, v93, v236
    v_mul_f32 v86, v86, v232
    v_mul_f32 v94, v94, v236
    v_mul_f32 v87, v87, v232
    v_mul_f32 v95, v95, v236
    v_cvt_pk_bf16_f32 v224, v80, v81
    v_cvt_pk_bf16_f32 v228, v88, v89
    v_cvt_pk_bf16_f32 v225, v82, v83
    v_cvt_pk_bf16_f32 v229, v90, v91
    v_cvt_pk_bf16_f32 v226, v84, v85
    v_cvt_pk_bf16_f32 v230, v92, v93
    v_cvt_pk_bf16_f32 v227, v86, v87
    v_cvt_pk_bf16_f32 v231, v94, v95
    s_nop 0
    v_mfma_f32_16x16x32_bf16 v[80:83], v[144:147], v[224:227], 0
    v_mfma_f32_16x16x32_bf16 v[84:87], v[148:151], v[224:227], 0
    v_mfma_f32_16x16x32_bf16 v[88:91], v[152:155], v[224:227], 0
    v_mfma_f32_16x16x32_bf16 v[92:95], v[156:159], v[224:227], 0
    v_mfma_f32_16x16x32_bf16 v[96:99], v[160:163], v[224:227], 0
    v_mfma_f32_16x16x32_bf16 v[100:103], v[164:167], v[224:227], 0
    v_mfma_f32_16x16x32_bf16 v[104:107], v[168:171], v[224:227], 0
    v_mfma_f32_16x16x32_bf16 v[108:111], v[172:175], v[224:227], 0
    v_mfma_f32_16x16x32_bf16 v[112:115], v[144:147], v[228:231], 0
    v_mfma_f32_16x16x32_bf16 v[116:119], v[148:151], v[228:231], 0
    v_mfma_f32_16x16x32_bf16 v[120:123], v[152:155], v[228:231], 0
    v_mfma_f32_16x16x32_bf16 v[124:127], v[156:159], v[228:231], 0
    v_mfma_f32_16x16x32_bf16 v[128:131], v[160:163], v[228:231], 0
    v_mfma_f32_16x16x32_bf16 v[132:135], v[164:167], v[228:231], 0
    v_mfma_f32_16x16x32_bf16 v[136:139], v[168:171], v[228:231], 0
    v_mfma_f32_16x16x32_bf16 v[140:143], v[172:175], v[228:231], 0
    v_cvt_pk_bf16_f32 v208, v80, v84
    v_cvt_pk_bf16_f32 v209, v88, v92
    v_cvt_pk_bf16_f32 v210, v96, v100
    v_cvt_pk_bf16_f32 v211, v104, v108
    ds_write_b128 v240, v[208:211] offset:32768
    v_cvt_pk_bf16_f32 v212, v81, v85
    v_cvt_pk_bf16_f32 v213, v89, v93
    v_cvt_pk_bf16_f32 v214, v97, v101
    v_cvt_pk_bf16_f32 v215, v105, v109
    ds_write_b128 v241, v[212:215] offset:32768
    v_cvt_pk_bf16_f32 v216, v82, v86
    v_cvt_pk_bf16_f32 v217, v90, v94
    v_cvt_pk_bf16_f32 v218, v98, v102
    v_cvt_pk_bf16_f32 v219, v106, v110
    ds_write_b128 v242, v[216:219] offset:32768
    v_cvt_pk_bf16_f32 v220, v83, v87
    v_cvt_pk_bf16_f32 v221, v91, v95
    v_cvt_pk_bf16_f32 v222, v99, v103
    v_cvt_pk_bf16_f32 v223, v107, v111
    ds_write_b128 v243, v[220:223] offset:32768
    v_cvt_pk_bf16_f32 v208, v112, v116
    v_cvt_pk_bf16_f32 v209, v120, v124
    v_cvt_pk_bf16_f32 v210, v128, v132
    v_cvt_pk_bf16_f32 v211, v136, v140
    ds_write_b128 v240, v[208:211] offset:49152
    v_cvt_pk_bf16_f32 v212, v113, v117
    v_cvt_pk_bf16_f32 v213, v121, v125
    v_cvt_pk_bf16_f32 v214, v129, v133
    v_cvt_pk_bf16_f32 v215, v137, v141
    ds_write_b128 v241, v[212:215] offset:49152
    v_cvt_pk_bf16_f32 v216, v114, v118
    v_cvt_pk_bf16_f32 v217, v122, v126
    v_cvt_pk_bf16_f32 v218, v130, v134
    v_cvt_pk_bf16_f32 v219, v138, v142
    ds_write_b128 v242, v[216:219] offset:49152
    v_cvt_pk_bf16_f32 v220, v115, v119
    v_cvt_pk_bf16_f32 v221, v123, v127
    v_cvt_pk_bf16_f32 v222, v131, v135
    v_cvt_pk_bf16_f32 v223, v139, v143
    ds_write_b128 v243, v[220:223] offset:49152
    v_mov_b32 v144, 0
    v_mov_b32 v145, 0
    v_mov_b32 v146, 0
    v_mov_b32 v147, 0
    s_nop 1
    v_mfma_f32_16x16x32_bf16 a[0:3], v[144:147], v[144:147], 0
    v_mfma_f32_16x16x32_bf16 a[4:7], v[144:147], v[144:147], 0
    v_mfma_f32_16x16x32_bf16 a[8:11], v[144:147], v[144:147], 0
    v_mfma_f32_16x16x32_bf16 a[12:15], v[144:147], v[144:147], 0
    v_mfma_f32_16x16x32_bf16 a[16:19], v[144:147], v[144:147], 0
    v_mfma_f32_16x16x32_bf16 a[20:23], v[144:147], v[144:147], 0
    v_mfma_f32_16x16x32_bf16 a[24:27], v[144:147], v[144:147], 0
    v_mfma_f32_16x16x32_bf16 a[28:31], v[144:147], v[144:147], 0
    v_mfma_f32_16x16x32_bf16 a[32:35], v[144:147], v[144:147], 0
    v_mfma_f32_16x16x32_bf16 a[36:39], v[144:147], v[144:147], 0
    v_mfma_f32_16x16x32_bf16 a[40:43], v[144:147], v[144:147], 0
    v_mfma_f32_16x16x32_bf16 a[44:47], v[144:147], v[144:147], 0
    v_mfma_f32_16x16x32_bf16 a[48:51], v[144:147], v[144:147], 0
    v_mfma_f32_16x16x32_bf16 a[52:55], v[144:147], v[144:147], 0
    v_mfma_f32_16x16x32_bf16 a[56:59], v[144:147], v[144:147], 0
    v_mfma_f32_16x16x32_bf16 a[60:63], v[144:147], v[144:147], 0
    v_mfma_f32_16x16x32_bf16 a[64:67], v[144:147], v[144:147], 0
    v_mfma_f32_16x16x32_bf16 a[68:71], v[144:147], v[144:147], 0
    v_mfma_f32_16x16x32_bf16 a[72:75], v[144:147], v[144:147], 0
    v_mfma_f32_16x16x32_bf16 a[76:79], v[144:147], v[144:147], 0
    v_mfma_f32_16x16x32_bf16 a[80:83], v[144:147], v[144:147], 0
    v_mfma_f32_16x16x32_bf16 a[84:87], v[144:147], v[144:147], 0
    v_mfma_f32_16x16x32_bf16 a[88:91], v[144:147], v[144:147], 0
    v_mfma_f32_16x16x32_bf16 a[92:95], v[144:147], v[144:147], 0
    v_mfma_f32_16x16x32_bf16 a[96:99], v[144:147], v[144:147], 0
    v_mfma_f32_16x16x32_bf16 a[100:103], v[144:147], v[144:147], 0
    v_mfma_f32_16x16x32_bf16 a[104:107], v[144:147], v[144:147], 0
    v_mfma_f32_16x16x32_bf16 a[108:111], v[144:147], v[144:147], 0
    v_mfma_f32_16x16x32_bf16 a[112:115], v[144:147], v[144:147], 0
    v_mfma_f32_16x16x32_bf16 a[116:119], v[144:147], v[144:147], 0
    v_mfma_f32_16x16x32_bf16 a[120:123], v[144:147], v[144:147], 0
    v_mfma_f32_16x16x32_bf16 a[124:127], v[144:147], v[144:147], 0
    s_mov_b32 s66, 0x400000
    s_add_u32 s68, s11, 0x10000
    buffer_load_dwordx4 v[80:83], v2, s[64:67], s68 offen
    buffer_load_dwordx4 v[84:87], v3, s[64:67], s68 offen
    buffer_load_dwordx4 v[88:91], v4, s[64:67], s68 offen
    buffer_load_dwordx4 v[92:95], v5, s[64:67], s68 offen
    buffer_load_dwordx4 v[96:99], v6, s[64:67], s68 offen
    buffer_load_dwordx4 v[100:103], v7, s[64:67], s68 offen
    buffer_load_dwordx4 v[104:107], v8, s[64:67], s68 offen
    buffer_load_dwordx4 v[108:111], v9, s[64:67], s68 offen
    s_add_u32 s68, s68, s69
    buffer_load_dwordx4 v[112:115], v2, s[64:67], s68 offen
    buffer_load_dwordx4 v[116:119], v3, s[64:67], s68 offen
    buffer_load_dwordx4 v[120:123], v4, s[64:67], s68 offen
    buffer_load_dwordx4 v[124:127], v5, s[64:67], s68 offen
    buffer_load_dwordx4 v[128:131], v6, s[64:67], s68 offen
    buffer_load_dwordx4 v[132:135], v7, s[64:67], s68 offen
    buffer_load_dwordx4 v[136:139], v8, s[64:67], s68 offen
    buffer_load_dwordx4 v[140:143], v9, s[64:67], s68 offen
    s_add_u32 s68, s68, s69
    s_waitcnt lgkmcnt(0)
    s_barrier
    ds_read_b128 a[128:131], v10 offset:0
    ds_read_b128 a[132:135], v10 offset:16384
    ds_read_b128 a[136:139], v10 offset:32768
    ds_read_b128 a[140:143], v10 offset:49152
    v_perm_b32 v144, v20, v16, s74
    v_perm_b32 v145, v28, v24, s74
    v_perm_b32 v146, v36, v32, s74
    v_perm_b32 v147, v44, v40, s74
    v_perm_b32 v148, v20, v16, s75
    v_perm_b32 v149, v28, v24, s75
    v_perm_b32 v150, v36, v32, s75
    v_perm_b32 v151, v44, v40, s75
    v_perm_b32 v152, v21, v17, s74
    v_perm_b32 v153, v29, v25, s74
    v_perm_b32 v154, v37, v33, s74
    v_perm_b32 v155, v45, v41, s74
    v_perm_b32 v156, v21, v17, s75
    v_perm_b32 v157, v29, v25, s75
    v_perm_b32 v158, v37, v33, s75
    v_perm_b32 v159, v45, v41, s75
    v_perm_b32 v160, v22, v18, s74
    v_perm_b32 v161, v30, v26, s74
    v_perm_b32 v162, v38, v34, s74
    v_perm_b32 v163, v46, v42, s74
    v_perm_b32 v164, v22, v18, s75
    v_perm_b32 v165, v30, v26, s75
    v_perm_b32 v166, v38, v34, s75
    v_perm_b32 v167, v46, v42, s75
    v_perm_b32 v168, v23, v19, s74
    v_perm_b32 v169, v31, v27, s74
    v_perm_b32 v170, v39, v35, s74
    v_perm_b32 v171, v47, v43, s74
    v_perm_b32 v172, v23, v19, s75
    v_perm_b32 v173, v31, v27, s75
    v_perm_b32 v174, v39, v35, s75
    v_perm_b32 v175, v47, v43, s75
    s_branch gemm_loop
epilogue:
    s_nop 9
    s_waitcnt vmcnt(0)
    v_accvgpr_read_b32 v16, a0
    v_accvgpr_read_b32 v17, a4
    v_accvgpr_read_b32 v18, a8
    v_accvgpr_read_b32 v19, a12
    v_accvgpr_read_b32 v20, a16
    v_accvgpr_read_b32 v21, a20
    v_accvgpr_read_b32 v22, a24
    v_accvgpr_read_b32 v23, a28
    v_accvgpr_read_b32 v24, a1
    v_accvgpr_read_b32 v25, a5
    v_accvgpr_read_b32 v26, a9
    v_accvgpr_read_b32 v27, a13
    v_accvgpr_read_b32 v28, a17
    v_accvgpr_read_b32 v29, a21
    v_accvgpr_read_b32 v30, a25
    v_accvgpr_read_b32 v31, a29
    v_accvgpr_read_b32 v32, a2
    v_accvgpr_read_b32 v33, a6
    v_accvgpr_read_b32 v34, a10
    v_accvgpr_read_b32 v35, a14
    v_accvgpr_read_b32 v36, a18
    v_accvgpr_read_b32 v37, a22
    v_accvgpr_read_b32 v38, a26
    v_accvgpr_read_b32 v39, a30
    v_accvgpr_read_b32 v40, a3
    v_accvgpr_read_b32 v41, a7
    v_accvgpr_read_b32 v42, a11
    v_accvgpr_read_b32 v43, a15
    v_accvgpr_read_b32 v44, a19
    v_accvgpr_read_b32 v45, a23
    v_accvgpr_read_b32 v46, a27
    v_accvgpr_read_b32 v47, a31
    v_accvgpr_read_b32 v48, a32
    v_accvgpr_read_b32 v49, a36
    v_accvgpr_read_b32 v50, a40
    v_accvgpr_read_b32 v51, a44
    v_accvgpr_read_b32 v52, a48
    v_accvgpr_read_b32 v53, a52
    v_accvgpr_read_b32 v54, a56
    v_accvgpr_read_b32 v55, a60
    v_accvgpr_read_b32 v56, a33
    v_accvgpr_read_b32 v57, a37
    v_accvgpr_read_b32 v58, a41
    v_accvgpr_read_b32 v59, a45
    v_accvgpr_read_b32 v60, a49
    v_accvgpr_read_b32 v61, a53
    v_accvgpr_read_b32 v62, a57
    v_accvgpr_read_b32 v63, a61
    v_accvgpr_read_b32 v64, a34
    v_accvgpr_read_b32 v65, a38
    v_accvgpr_read_b32 v66, a42
    v_accvgpr_read_b32 v67, a46
    v_accvgpr_read_b32 v68, a50
    v_accvgpr_read_b32 v69, a54
    v_accvgpr_read_b32 v70, a58
    v_accvgpr_read_b32 v71, a62
    v_accvgpr_read_b32 v72, a35
    v_accvgpr_read_b32 v73, a39
    v_accvgpr_read_b32 v74, a43
    v_accvgpr_read_b32 v75, a47
    v_accvgpr_read_b32 v76, a51
    v_accvgpr_read_b32 v77, a55
    v_accvgpr_read_b32 v78, a59
    v_accvgpr_read_b32 v79, a63
    v_accvgpr_read_b32 v80, a64
    v_accvgpr_read_b32 v81, a68
    v_accvgpr_read_b32 v82, a72
    v_accvgpr_read_b32 v83, a76
    v_accvgpr_read_b32 v84, a80
    v_accvgpr_read_b32 v85, a84
    v_accvgpr_read_b32 v86, a88
    v_accvgpr_read_b32 v87, a92
    v_accvgpr_read_b32 v88, a65
    v_accvgpr_read_b32 v89, a69
    v_accvgpr_read_b32 v90, a73
    v_accvgpr_read_b32 v91, a77
    v_accvgpr_read_b32 v92, a81
    v_accvgpr_read_b32 v93, a85
    v_accvgpr_read_b32 v94, a89
    v_accvgpr_read_b32 v95, a93
    v_accvgpr_read_b32 v96, a66
    v_accvgpr_read_b32 v97, a70
    v_accvgpr_read_b32 v98, a74
    v_accvgpr_read_b32 v99, a78
    v_accvgpr_read_b32 v100, a82
    v_accvgpr_read_b32 v101, a86
    v_accvgpr_read_b32 v102, a90
    v_accvgpr_read_b32 v103, a94
    v_accvgpr_read_b32 v104, a67
    v_accvgpr_read_b32 v105, a71
    v_accvgpr_read_b32 v106, a75
    v_accvgpr_read_b32 v107, a79
    v_accvgpr_read_b32 v108, a83
    v_accvgpr_read_b32 v109, a87
    v_accvgpr_read_b32 v110, a91
    v_accvgpr_read_b32 v111, a95
    v_accvgpr_read_b32 v112, a96
    v_accvgpr_read_b32 v113, a100
    v_accvgpr_read_b32 v114, a104
    v_accvgpr_read_b32 v115, a108
    v_accvgpr_read_b32 v116, a112
    v_accvgpr_read_b32 v117, a116
    v_accvgpr_read_b32 v118, a120
    v_accvgpr_read_b32 v119, a124
    v_accvgpr_read_b32 v120, a97
    v_accvgpr_read_b32 v121, a101
    v_accvgpr_read_b32 v122, a105
    v_accvgpr_read_b32 v123, a109
    v_accvgpr_read_b32 v124, a113
    v_accvgpr_read_b32 v125, a117
    v_accvgpr_read_b32 v126, a121
    v_accvgpr_read_b32 v127, a125
    v_accvgpr_read_b32 v128, a98
    v_accvgpr_read_b32 v129, a102
    v_accvgpr_read_b32 v130, a106
    v_accvgpr_read_b32 v131, a110
    v_accvgpr_read_b32 v132, a114
    v_accvgpr_read_b32 v133, a118
    v_accvgpr_read_b32 v134, a122
    v_accvgpr_read_b32 v135, a126
    v_accvgpr_read_b32 v136, a99
    v_accvgpr_read_b32 v137, a103
    v_accvgpr_read_b32 v138, a107
    v_accvgpr_read_b32 v139, a111
    v_accvgpr_read_b32 v140, a115
    v_accvgpr_read_b32 v141, a119
    v_accvgpr_read_b32 v142, a123
    v_accvgpr_read_b32 v143, a127
    v_max3_f32 v245, |v16|, |v17|, |v18|
    v_max3_f32 v246, |v19|, |v20|, |v21|
    v_max3_f32 v245, |v22|, |v23|, v245
    v_max3_f32 v246, |v24|, |v25|, v246
    v_max3_f32 v245, |v26|, |v27|, v245
    v_max3_f32 v246, |v28|, |v29|, v246
    v_max3_f32 v245, |v30|, |v31|, v245
    v_max3_f32 v246, |v32|, |v33|, v246
    v_max3_f32 v245, |v34|, |v35|, v245
    v_max3_f32 v246, |v36|, |v37|, v246
    v_max3_f32 v245, |v38|, |v39|, v245
    v_max3_f32 v246, |v40|, |v41|, v246
    v_max3_f32 v245, |v42|, |v43|, v245
    v_max3_f32 v246, |v44|, |v45|, v246
    v_max3_f32 v245, |v46|, |v47|, v245
    v_max3_f32 v246, |v48|, |v49|, v246
    v_max3_f32 v245, |v50|, |v51|, v245
    v_max3_f32 v246, |v52|, |v53|, v246
    v_max3_f32 v245, |v54|, |v55|, v245
    v_max3_f32 v246, |v56|, |v57|, v246
    v_max3_f32 v245, |v58|, |v59|, v245
    v_max3_f32 v246, |v60|, |v61|, v246
    v_max3_f32 v245, |v62|, |v63|, v245
    v_max3_f32 v246, |v64|, |v65|, v246
    v_max3_f32 v245, |v66|, |v67|, v245
    v_max3_f32 v246, |v68|, |v69|, v246
    v_max3_f32 v245, |v70|, |v71|, v245
    v_max3_f32 v246, |v72|, |v73|, v246
    v_max3_f32 v245, |v74|, |v75|, v245
    v_max3_f32 v246, |v76|, |v77|, v246
    v_max3_f32 v245, |v78|, |v79|, v245
    v_max3_f32 v246, |v80|, |v81|, v246
    v_max3_f32 v245, |v82|, |v83|, v245
    v_max3_f32 v246, |v84|, |v85|, v246
    v_max3_f32 v245, |v86|, |v87|, v245
    v_max3_f32 v246, |v88|, |v89|, v246
    v_max3_f32 v245, |v90|, |v91|, v245
    v_max3_f32 v246, |v92|, |v93|, v246
    v_max3_f32 v245, |v94|, |v95|, v245
    v_max3_f32 v246, |v96|, |v97|, v246
    v_max3_f32 v245, |v98|, |v99|, v245
    v_max3_f32 v246, |v100|, |v101|, v246
    v_max3_f32 v245, |v102|, |v103|, v245
    v_max3_f32 v246, |v104|, |v105|, v246
    v_max3_f32 v245, |v106|, |v107|, v245
    v_max3_f32 v246, |v108|, |v109|, v246
    v_max3_f32 v245, |v110|, |v111|, v245
    v_max3_f32 v246, |v112|, |v113|, v246
    v_max3_f32 v245, |v114|, |v115|, v245
    v_max3_f32 v246, |v116|, |v117|, v246
    v_max3_f32 v245, |v118|, |v119|, v245
    v_max3_f32 v246, |v120|, |v121|, v246
    v_max3_f32 v245, |v122|, |v123|, v245
    v_max3_f32 v246, |v124|, |v125|, v246
    v_max3_f32 v245, |v126|, |v127|, v245
    v_max3_f32 v246, |v128|, |v129|, v246
    v_max3_f32 v245, |v130|, |v131|, v245
    v_max3_f32 v246, |v132|, |v133|, v246
    v_max3_f32 v245, |v134|, |v135|, v245
    v_max3_f32 v246, |v136|, |v137|, v246
    v_max3_f32 v245, |v138|, |v139|, v245
    v_max3_f32 v246, |v140|, |v141|, v246
    v_max3_f32 v245, |v142|, |v143|, v245
    v_max_f32 v245, v245, v246
    v_frexp_exp_i32_f32 v246, v245
    v_sub_u32 v246, 15, v246
    s_movk_i32 s3, 0xff82
    s_movk_i32 s13, 126
    v_mov_b32 v247, s13
    v_med3_i32 v246, v246, s3, v247
    v_ldexp_f32 v248, 1.0, v246
    v_mov_b32 v249, v248
    v_sub_u32 v246, 0, v246
    v_ldexp_f32 v250, 1.0, v246
    s_lshr_b32 s3, s76, 7
    s_add_u32 s3, s3, 0x1000000
    v_lshlrev_b32 v251, 2, v1
    buffer_store_dword v250, v251, s[60:63], s3 offen sc1
    s_lshr_b32 s76, s76, 1
    v_pk_mul_f32 v[16:17], v[16:17], v[248:249]
    v_pk_mul_f32 v[18:19], v[18:19], v[248:249]
    v_pk_mul_f32 v[20:21], v[20:21], v[248:249]
    v_pk_mul_f32 v[22:23], v[22:23], v[248:249]
    v_cvt_pk_f16_f32 v144, v16, v17
    v_cvt_pk_f16_f32 v145, v18, v19
    v_cvt_pk_f16_f32 v146, v20, v21
    v_cvt_pk_f16_f32 v147, v22, v23
    buffer_store_dwordx4 v[144:147], v244, s[60:63], s76 offen offset:0 sc1
    v_pk_mul_f32 v[24:25], v[24:25], v[248:249]
    v_pk_mul_f32 v[26:27], v[26:27], v[248:249]
    v_pk_mul_f32 v[28:29], v[28:29], v[248:249]
    v_pk_mul_f32 v[30:31], v[30:31], v[248:249]
    v_cvt_pk_f16_f32 v148, v24, v25
    v_cvt_pk_f16_f32 v149, v26, v27
    v_cvt_pk_f16_f32 v150, v28, v29
    v_cvt_pk_f16_f32 v151, v30, v31
    buffer_store_dwordx4 v[148:151], v244, s[60:63], s76 offen offset:1024 sc1
    v_pk_mul_f32 v[32:33], v[32:33], v[248:249]
    v_pk_mul_f32 v[34:35], v[34:35], v[248:249]
    v_pk_mul_f32 v[36:37], v[36:37], v[248:249]
    v_pk_mul_f32 v[38:39], v[38:39], v[248:249]
    v_cvt_pk_f16_f32 v152, v32, v33
    v_cvt_pk_f16_f32 v153, v34, v35
    v_cvt_pk_f16_f32 v154, v36, v37
    v_cvt_pk_f16_f32 v155, v38, v39
    buffer_store_dwordx4 v[152:155], v244, s[60:63], s76 offen offset:2048 sc1
    v_pk_mul_f32 v[40:41], v[40:41], v[248:249]
    v_pk_mul_f32 v[42:43], v[42:43], v[248:249]
    v_pk_mul_f32 v[44:45], v[44:45], v[248:249]
    v_pk_mul_f32 v[46:47], v[46:47], v[248:249]
    v_cvt_pk_f16_f32 v156, v40, v41
    v_cvt_pk_f16_f32 v157, v42, v43
    v_cvt_pk_f16_f32 v158, v44, v45
    v_cvt_pk_f16_f32 v159, v46, v47
    buffer_store_dwordx4 v[156:159], v244, s[60:63], s76 offen offset:3072 sc1
    s_add_u32 s76, s76, 0x1000
    v_pk_mul_f32 v[48:49], v[48:49], v[248:249]
    v_pk_mul_f32 v[50:51], v[50:51], v[248:249]
    v_pk_mul_f32 v[52:53], v[52:53], v[248:249]
    v_pk_mul_f32 v[54:55], v[54:55], v[248:249]
    v_cvt_pk_f16_f32 v160, v48, v49
    v_cvt_pk_f16_f32 v161, v50, v51
    v_cvt_pk_f16_f32 v162, v52, v53
    v_cvt_pk_f16_f32 v163, v54, v55
    buffer_store_dwordx4 v[160:163], v244, s[60:63], s76 offen offset:0 sc1
    v_pk_mul_f32 v[56:57], v[56:57], v[248:249]
    v_pk_mul_f32 v[58:59], v[58:59], v[248:249]
    v_pk_mul_f32 v[60:61], v[60:61], v[248:249]
    v_pk_mul_f32 v[62:63], v[62:63], v[248:249]
    v_cvt_pk_f16_f32 v164, v56, v57
    v_cvt_pk_f16_f32 v165, v58, v59
    v_cvt_pk_f16_f32 v166, v60, v61
    v_cvt_pk_f16_f32 v167, v62, v63
    buffer_store_dwordx4 v[164:167], v244, s[60:63], s76 offen offset:1024 sc1
    v_pk_mul_f32 v[64:65], v[64:65], v[248:249]
    v_pk_mul_f32 v[66:67], v[66:67], v[248:249]
    v_pk_mul_f32 v[68:69], v[68:69], v[248:249]
    v_pk_mul_f32 v[70:71], v[70:71], v[248:249]
    v_cvt_pk_f16_f32 v168, v64, v65
    v_cvt_pk_f16_f32 v169, v66, v67
    v_cvt_pk_f16_f32 v170, v68, v69
    v_cvt_pk_f16_f32 v171, v70, v71
    buffer_store_dwordx4 v[168:171], v244, s[60:63], s76 offen offset:2048 sc1
    v_pk_mul_f32 v[72:73], v[72:73], v[248:249]
    v_pk_mul_f32 v[74:75], v[74:75], v[248:249]
    v_pk_mul_f32 v[76:77], v[76:77], v[248:249]
    v_pk_mul_f32 v[78:79], v[78:79], v[248:249]
    v_cvt_pk_f16_f32 v172, v72, v73
    v_cvt_pk_f16_f32 v173, v74, v75
    v_cvt_pk_f16_f32 v174, v76, v77
    v_cvt_pk_f16_f32 v175, v78, v79
    buffer_store_dwordx4 v[172:175], v244, s[60:63], s76 offen offset:3072 sc1
    s_add_u32 s76, s76, 0x1000
    v_pk_mul_f32 v[80:81], v[80:81], v[248:249]
    v_pk_mul_f32 v[82:83], v[82:83], v[248:249]
    v_pk_mul_f32 v[84:85], v[84:85], v[248:249]
    v_pk_mul_f32 v[86:87], v[86:87], v[248:249]
    v_cvt_pk_f16_f32 v144, v80, v81
    v_cvt_pk_f16_f32 v145, v82, v83
    v_cvt_pk_f16_f32 v146, v84, v85
    v_cvt_pk_f16_f32 v147, v86, v87
    buffer_store_dwordx4 v[144:147], v244, s[60:63], s76 offen offset:0 sc1
    v_pk_mul_f32 v[88:89], v[88:89], v[248:249]
    v_pk_mul_f32 v[90:91], v[90:91], v[248:249]
    v_pk_mul_f32 v[92:93], v[92:93], v[248:249]
    v_pk_mul_f32 v[94:95], v[94:95], v[248:249]
    v_cvt_pk_f16_f32 v148, v88, v89
    v_cvt_pk_f16_f32 v149, v90, v91
    v_cvt_pk_f16_f32 v150, v92, v93
    v_cvt_pk_f16_f32 v151, v94, v95
    buffer_store_dwordx4 v[148:151], v244, s[60:63], s76 offen offset:1024 sc1
    v_pk_mul_f32 v[96:97], v[96:97], v[248:249]
    v_pk_mul_f32 v[98:99], v[98:99], v[248:249]
    v_pk_mul_f32 v[100:101], v[100:101], v[248:249]
    v_pk_mul_f32 v[102:103], v[102:103], v[248:249]
    v_cvt_pk_f16_f32 v152, v96, v97
    v_cvt_pk_f16_f32 v153, v98, v99
    v_cvt_pk_f16_f32 v154, v100, v101
    v_cvt_pk_f16_f32 v155, v102, v103
    buffer_store_dwordx4 v[152:155], v244, s[60:63], s76 offen offset:2048 sc1
    v_pk_mul_f32 v[104:105], v[104:105], v[248:249]
    v_pk_mul_f32 v[106:107], v[106:107], v[248:249]
    v_pk_mul_f32 v[108:109], v[108:109], v[248:249]
    v_pk_mul_f32 v[110:111], v[110:111], v[248:249]
    v_cvt_pk_f16_f32 v156, v104, v105
    v_cvt_pk_f16_f32 v157, v106, v107
    v_cvt_pk_f16_f32 v158, v108, v109
    v_cvt_pk_f16_f32 v159, v110, v111
    buffer_store_dwordx4 v[156:159], v244, s[60:63], s76 offen offset:3072 sc1
    s_add_u32 s76, s76, 0x1000
    v_pk_mul_f32 v[112:113], v[112:113], v[248:249]
    v_pk_mul_f32 v[114:115], v[114:115], v[248:249]
    v_pk_mul_f32 v[116:117], v[116:117], v[248:249]
    v_pk_mul_f32 v[118:119], v[118:119], v[248:249]
    v_cvt_pk_f16_f32 v160, v112, v113
    v_cvt_pk_f16_f32 v161, v114, v115
    v_cvt_pk_f16_f32 v162, v116, v117
    v_cvt_pk_f16_f32 v163, v118, v119
    buffer_store_dwordx4 v[160:163], v244, s[60:63], s76 offen offset:0 sc1
    v_pk_mul_f32 v[120:121], v[120:121], v[248:249]
    v_pk_mul_f32 v[122:123], v[122:123], v[248:249]
    v_pk_mul_f32 v[124:125], v[124:125], v[248:249]
    v_pk_mul_f32 v[126:127], v[126:127], v[248:249]
    v_cvt_pk_f16_f32 v164, v120, v121
    v_cvt_pk_f16_f32 v165, v122, v123
    v_cvt_pk_f16_f32 v166, v124, v125
    v_cvt_pk_f16_f32 v167, v126, v127
    buffer_store_dwordx4 v[164:167], v244, s[60:63], s76 offen offset:1024 sc1
    v_pk_mul_f32 v[128:129], v[128:129], v[248:249]
    v_pk_mul_f32 v[130:131], v[130:131], v[248:249]
    v_pk_mul_f32 v[132:133], v[132:133], v[248:249]
    v_pk_mul_f32 v[134:135], v[134:135], v[248:249]
    v_cvt_pk_f16_f32 v168, v128, v129
    v_cvt_pk_f16_f32 v169, v130, v131
    v_cvt_pk_f16_f32 v170, v132, v133
    v_cvt_pk_f16_f32 v171, v134, v135
    buffer_store_dwordx4 v[168:171], v244, s[60:63], s76 offen offset:2048 sc1
    v_pk_mul_f32 v[136:137], v[136:137], v[248:249]
    v_pk_mul_f32 v[138:139], v[138:139], v[248:249]
    v_pk_mul_f32 v[140:141], v[140:141], v[248:249]
    v_pk_mul_f32 v[142:143], v[142:143], v[248:249]
    v_cvt_pk_f16_f32 v172, v136, v137
    v_cvt_pk_f16_f32 v173, v138, v139
    v_cvt_pk_f16_f32 v174, v140, v141
    v_cvt_pk_f16_f32 v175, v142, v143
    buffer_store_dwordx4 v[172:175], v244, s[60:63], s76 offen offset:3072 sc1
main_done:
    s_endpgm
.globl reduce_kernel
.p2align 8
.type reduce_kernel,@function
reduce_kernel:
    s_cmp_ge_u32 s2, 256
    s_cbranch_scc1 reduce_done
    s_load_dwordx2 s[8:9], s[0:1], 80
    s_load_dwordx2 s[12:13], s[0:1], 96
    v_lshrrev_b32 v2, 6, v0
    v_and_b32 v1, 63, v0
    v_readfirstlane_b32 s7, v2
    v_lshlrev_b32 v3, 4, v1
    v_and_b32 v4, 15, v1
    v_lshrrev_b32 v5, 4, v1
    v_lshlrev_b32 v5, 6, v5
    v_lshl_add_u32 v4, v4, 11, v5
    s_nop 2
    s_lshl_b32 s3, s2, 2
    s_add_u32 s3, s3, s7
    s_and_b32 s20, s3, 1
    s_lshr_b32 s21, s3, 1
    s_and_b32 s21, s21, 3
    s_lshr_b32 s22, s3, 3
    s_and_b32 s22, s22, 3
    s_lshr_b32 s23, s3, 5
    s_and_b32 s23, s23, 15
    s_lshr_b32 s24, s3, 9
    s_lshl_b32 s25, s24, 4
    s_add_u32 s25, s25, s23
    s_lshl_b32 s25, s25, 5
    s_add_u32 s25, s25, s22
    s_lshl_b32 s25, s25, 14
    s_lshl_b32 s26, s21, 12
    s_add_u32 s25, s25, s26
    s_lshl_b32 s26, s20, 11
    s_add_u32 s25, s25, s26
    s_lshl_b32 s27, s23, 17
    s_lshl_b32 s26, s21, 15
    s_add_u32 s27, s27, s26
    s_lshl_b32 s26, s24, 10
    s_add_u32 s27, s27, s26
    s_lshl_b32 s26, s22, 8
    s_add_u32 s27, s27, s26
    s_lshl_b32 s26, s20, 5
    s_add_u32 s27, s27, s26
    s_mov_b32 s28, 0xffff0000
    s_waitcnt lgkmcnt(0)
    s_mov_b32 s10, 0x200000
    s_mov_b32 s11, 0x00020000
    s_mov_b32 s14, 0x2000000
    s_mov_b32 s15, 0x00020000
    s_lshl_b32 s29, s24, 4
    s_add_u32 s29, s29, s23
    s_lshl_b32 s29, s29, 5
    s_add_u32 s29, s29, s22
    s_lshl_b32 s29, s29, 8
    s_add_u32 s29, s29, 0x1000000
    v_lshlrev_b32 v6, 2, v1
    buffer_load_dword v96, v6, s[12:15], s29 offen
    s_add_u32 s29, s29, 1024
    buffer_load_dwordx4 v[32:35], v3, s[12:15], s25 offen offset:0
    buffer_load_dwordx4 v[36:39], v3, s[12:15], s25 offen offset:1024
    s_add_u32 s25, s25, 0x10000
    buffer_load_dword v97, v6, s[12:15], s29 offen
    s_add_u32 s29, s29, 1024
    buffer_load_dwordx4 v[40:43], v3, s[12:15], s25 offen offset:0
    buffer_load_dwordx4 v[44:47], v3, s[12:15], s25 offen offset:1024
    s_add_u32 s25, s25, 0x10000
    buffer_load_dword v98, v6, s[12:15], s29 offen
    s_add_u32 s29, s29, 1024
    buffer_load_dwordx4 v[48:51], v3, s[12:15], s25 offen offset:0
    buffer_load_dwordx4 v[52:55], v3, s[12:15], s25 offen offset:1024
    s_add_u32 s25, s25, 0x10000
    buffer_load_dword v99, v6, s[12:15], s29 offen
    s_add_u32 s29, s29, 1024
    buffer_load_dwordx4 v[56:59], v3, s[12:15], s25 offen offset:0
    buffer_load_dwordx4 v[60:63], v3, s[12:15], s25 offen offset:1024
    s_add_u32 s25, s25, 0x10000
    buffer_load_dword v100, v6, s[12:15], s29 offen
    s_add_u32 s29, s29, 1024
    buffer_load_dwordx4 v[64:67], v3, s[12:15], s25 offen offset:0
    buffer_load_dwordx4 v[68:71], v3, s[12:15], s25 offen offset:1024
    s_add_u32 s25, s25, 0x10000
    buffer_load_dword v101, v6, s[12:15], s29 offen
    s_add_u32 s29, s29, 1024
    buffer_load_dwordx4 v[72:75], v3, s[12:15], s25 offen offset:0
    buffer_load_dwordx4 v[76:79], v3, s[12:15], s25 offen offset:1024
    s_add_u32 s25, s25, 0x10000
    buffer_load_dword v102, v6, s[12:15], s29 offen
    s_add_u32 s29, s29, 1024
    buffer_load_dwordx4 v[80:83], v3, s[12:15], s25 offen offset:0
    buffer_load_dwordx4 v[84:87], v3, s[12:15], s25 offen offset:1024
    s_add_u32 s25, s25, 0x10000
    buffer_load_dword v103, v6, s[12:15], s29 offen
    s_add_u32 s29, s29, 1024
    buffer_load_dwordx4 v[88:91], v3, s[12:15], s25 offen offset:0
    buffer_load_dwordx4 v[92:95], v3, s[12:15], s25 offen offset:1024
    v_mov_b32 v8, 0
    v_mov_b32 v9, 0
    v_mov_b32 v10, 0
    v_mov_b32 v11, 0
    v_mov_b32 v12, 0
    v_mov_b32 v13, 0
    v_mov_b32 v14, 0
    v_mov_b32 v15, 0
    v_mov_b32 v16, 0
    v_mov_b32 v17, 0
    v_mov_b32 v18, 0
    v_mov_b32 v19, 0
    v_mov_b32 v20, 0
    v_mov_b32 v21, 0
    v_mov_b32 v22, 0
    v_mov_b32 v23, 0
    s_waitcnt vmcnt(21)
    v_fma_mix_f32 v8, v32, v96, v8 op_sel_hi:[1,0,0]
    v_fma_mix_f32 v9, v32, v96, v9 op_sel:[1,0,0] op_sel_hi:[1,0,0]
    v_fma_mix_f32 v10, v33, v96, v10 op_sel_hi:[1,0,0]
    v_fma_mix_f32 v11, v33, v96, v11 op_sel:[1,0,0] op_sel_hi:[1,0,0]
    v_fma_mix_f32 v12, v34, v96, v12 op_sel_hi:[1,0,0]
    v_fma_mix_f32 v13, v34, v96, v13 op_sel:[1,0,0] op_sel_hi:[1,0,0]
    v_fma_mix_f32 v14, v35, v96, v14 op_sel_hi:[1,0,0]
    v_fma_mix_f32 v15, v35, v96, v15 op_sel:[1,0,0] op_sel_hi:[1,0,0]
    v_fma_mix_f32 v16, v36, v96, v16 op_sel_hi:[1,0,0]
    v_fma_mix_f32 v17, v36, v96, v17 op_sel:[1,0,0] op_sel_hi:[1,0,0]
    v_fma_mix_f32 v18, v37, v96, v18 op_sel_hi:[1,0,0]
    v_fma_mix_f32 v19, v37, v96, v19 op_sel:[1,0,0] op_sel_hi:[1,0,0]
    v_fma_mix_f32 v20, v38, v96, v20 op_sel_hi:[1,0,0]
    v_fma_mix_f32 v21, v38, v96, v21 op_sel:[1,0,0] op_sel_hi:[1,0,0]
    v_fma_mix_f32 v22, v39, v96, v22 op_sel_hi:[1,0,0]
    v_fma_mix_f32 v23, v39, v96, v23 op_sel:[1,0,0] op_sel_hi:[1,0,0]
    s_waitcnt vmcnt(18)
    v_fma_mix_f32 v8, v40, v97, v8 op_sel_hi:[1,0,0]
    v_fma_mix_f32 v9, v40, v97, v9 op_sel:[1,0,0] op_sel_hi:[1,0,0]
    v_fma_mix_f32 v10, v41, v97, v10 op_sel_hi:[1,0,0]
    v_fma_mix_f32 v11, v41, v97, v11 op_sel:[1,0,0] op_sel_hi:[1,0,0]
    v_fma_mix_f32 v12, v42, v97, v12 op_sel_hi:[1,0,0]
    v_fma_mix_f32 v13, v42, v97, v13 op_sel:[1,0,0] op_sel_hi:[1,0,0]
    v_fma_mix_f32 v14, v43, v97, v14 op_sel_hi:[1,0,0]
    v_fma_mix_f32 v15, v43, v97, v15 op_sel:[1,0,0] op_sel_hi:[1,0,0]
    v_fma_mix_f32 v16, v44, v97, v16 op_sel_hi:[1,0,0]
    v_fma_mix_f32 v17, v44, v97, v17 op_sel:[1,0,0] op_sel_hi:[1,0,0]
    v_fma_mix_f32 v18, v45, v97, v18 op_sel_hi:[1,0,0]
    v_fma_mix_f32 v19, v45, v97, v19 op_sel:[1,0,0] op_sel_hi:[1,0,0]
    v_fma_mix_f32 v20, v46, v97, v20 op_sel_hi:[1,0,0]
    v_fma_mix_f32 v21, v46, v97, v21 op_sel:[1,0,0] op_sel_hi:[1,0,0]
    v_fma_mix_f32 v22, v47, v97, v22 op_sel_hi:[1,0,0]
    v_fma_mix_f32 v23, v47, v97, v23 op_sel:[1,0,0] op_sel_hi:[1,0,0]
    s_waitcnt vmcnt(15)
    v_fma_mix_f32 v8, v48, v98, v8 op_sel_hi:[1,0,0]
    v_fma_mix_f32 v9, v48, v98, v9 op_sel:[1,0,0] op_sel_hi:[1,0,0]
    v_fma_mix_f32 v10, v49, v98, v10 op_sel_hi:[1,0,0]
    v_fma_mix_f32 v11, v49, v98, v11 op_sel:[1,0,0] op_sel_hi:[1,0,0]
    v_fma_mix_f32 v12, v50, v98, v12 op_sel_hi:[1,0,0]
    v_fma_mix_f32 v13, v50, v98, v13 op_sel:[1,0,0] op_sel_hi:[1,0,0]
    v_fma_mix_f32 v14, v51, v98, v14 op_sel_hi:[1,0,0]
    v_fma_mix_f32 v15, v51, v98, v15 op_sel:[1,0,0] op_sel_hi:[1,0,0]
    v_fma_mix_f32 v16, v52, v98, v16 op_sel_hi:[1,0,0]
    v_fma_mix_f32 v17, v52, v98, v17 op_sel:[1,0,0] op_sel_hi:[1,0,0]
    v_fma_mix_f32 v18, v53, v98, v18 op_sel_hi:[1,0,0]
    v_fma_mix_f32 v19, v53, v98, v19 op_sel:[1,0,0] op_sel_hi:[1,0,0]
    v_fma_mix_f32 v20, v54, v98, v20 op_sel_hi:[1,0,0]
    v_fma_mix_f32 v21, v54, v98, v21 op_sel:[1,0,0] op_sel_hi:[1,0,0]
    v_fma_mix_f32 v22, v55, v98, v22 op_sel_hi:[1,0,0]
    v_fma_mix_f32 v23, v55, v98, v23 op_sel:[1,0,0] op_sel_hi:[1,0,0]
    s_waitcnt vmcnt(12)
    v_fma_mix_f32 v8, v56, v99, v8 op_sel_hi:[1,0,0]
    v_fma_mix_f32 v9, v56, v99, v9 op_sel:[1,0,0] op_sel_hi:[1,0,0]
    v_fma_mix_f32 v10, v57, v99, v10 op_sel_hi:[1,0,0]
    v_fma_mix_f32 v11, v57, v99, v11 op_sel:[1,0,0] op_sel_hi:[1,0,0]
    v_fma_mix_f32 v12, v58, v99, v12 op_sel_hi:[1,0,0]
    v_fma_mix_f32 v13, v58, v99, v13 op_sel:[1,0,0] op_sel_hi:[1,0,0]
    v_fma_mix_f32 v14, v59, v99, v14 op_sel_hi:[1,0,0]
    v_fma_mix_f32 v15, v59, v99, v15 op_sel:[1,0,0] op_sel_hi:[1,0,0]
    v_fma_mix_f32 v16, v60, v99, v16 op_sel_hi:[1,0,0]
    v_fma_mix_f32 v17, v60, v99, v17 op_sel:[1,0,0] op_sel_hi:[1,0,0]
    v_fma_mix_f32 v18, v61, v99, v18 op_sel_hi:[1,0,0]
    v_fma_mix_f32 v19, v61, v99, v19 op_sel:[1,0,0] op_sel_hi:[1,0,0]
    v_fma_mix_f32 v20, v62, v99, v20 op_sel_hi:[1,0,0]
    v_fma_mix_f32 v21, v62, v99, v21 op_sel:[1,0,0] op_sel_hi:[1,0,0]
    v_fma_mix_f32 v22, v63, v99, v22 op_sel_hi:[1,0,0]
    v_fma_mix_f32 v23, v63, v99, v23 op_sel:[1,0,0] op_sel_hi:[1,0,0]
    s_waitcnt vmcnt(9)
    v_fma_mix_f32 v8, v64, v100, v8 op_sel_hi:[1,0,0]
    v_fma_mix_f32 v9, v64, v100, v9 op_sel:[1,0,0] op_sel_hi:[1,0,0]
    v_fma_mix_f32 v10, v65, v100, v10 op_sel_hi:[1,0,0]
    v_fma_mix_f32 v11, v65, v100, v11 op_sel:[1,0,0] op_sel_hi:[1,0,0]
    v_fma_mix_f32 v12, v66, v100, v12 op_sel_hi:[1,0,0]
    v_fma_mix_f32 v13, v66, v100, v13 op_sel:[1,0,0] op_sel_hi:[1,0,0]
    v_fma_mix_f32 v14, v67, v100, v14 op_sel_hi:[1,0,0]
    v_fma_mix_f32 v15, v67, v100, v15 op_sel:[1,0,0] op_sel_hi:[1,0,0]
    v_fma_mix_f32 v16, v68, v100, v16 op_sel_hi:[1,0,0]
    v_fma_mix_f32 v17, v68, v100, v17 op_sel:[1,0,0] op_sel_hi:[1,0,0]
    v_fma_mix_f32 v18, v69, v100, v18 op_sel_hi:[1,0,0]
    v_fma_mix_f32 v19, v69, v100, v19 op_sel:[1,0,0] op_sel_hi:[1,0,0]
    v_fma_mix_f32 v20, v70, v100, v20 op_sel_hi:[1,0,0]
    v_fma_mix_f32 v21, v70, v100, v21 op_sel:[1,0,0] op_sel_hi:[1,0,0]
    v_fma_mix_f32 v22, v71, v100, v22 op_sel_hi:[1,0,0]
    v_fma_mix_f32 v23, v71, v100, v23 op_sel:[1,0,0] op_sel_hi:[1,0,0]
    s_waitcnt vmcnt(6)
    v_fma_mix_f32 v8, v72, v101, v8 op_sel_hi:[1,0,0]
    v_fma_mix_f32 v9, v72, v101, v9 op_sel:[1,0,0] op_sel_hi:[1,0,0]
    v_fma_mix_f32 v10, v73, v101, v10 op_sel_hi:[1,0,0]
    v_fma_mix_f32 v11, v73, v101, v11 op_sel:[1,0,0] op_sel_hi:[1,0,0]
    v_fma_mix_f32 v12, v74, v101, v12 op_sel_hi:[1,0,0]
    v_fma_mix_f32 v13, v74, v101, v13 op_sel:[1,0,0] op_sel_hi:[1,0,0]
    v_fma_mix_f32 v14, v75, v101, v14 op_sel_hi:[1,0,0]
    v_fma_mix_f32 v15, v75, v101, v15 op_sel:[1,0,0] op_sel_hi:[1,0,0]
    v_fma_mix_f32 v16, v76, v101, v16 op_sel_hi:[1,0,0]
    v_fma_mix_f32 v17, v76, v101, v17 op_sel:[1,0,0] op_sel_hi:[1,0,0]
    v_fma_mix_f32 v18, v77, v101, v18 op_sel_hi:[1,0,0]
    v_fma_mix_f32 v19, v77, v101, v19 op_sel:[1,0,0] op_sel_hi:[1,0,0]
    v_fma_mix_f32 v20, v78, v101, v20 op_sel_hi:[1,0,0]
    v_fma_mix_f32 v21, v78, v101, v21 op_sel:[1,0,0] op_sel_hi:[1,0,0]
    v_fma_mix_f32 v22, v79, v101, v22 op_sel_hi:[1,0,0]
    v_fma_mix_f32 v23, v79, v101, v23 op_sel:[1,0,0] op_sel_hi:[1,0,0]
    s_waitcnt vmcnt(3)
    v_fma_mix_f32 v8, v80, v102, v8 op_sel_hi:[1,0,0]
    v_fma_mix_f32 v9, v80, v102, v9 op_sel:[1,0,0] op_sel_hi:[1,0,0]
    v_fma_mix_f32 v10, v81, v102, v10 op_sel_hi:[1,0,0]
    v_fma_mix_f32 v11, v81, v102, v11 op_sel:[1,0,0] op_sel_hi:[1,0,0]
    v_fma_mix_f32 v12, v82, v102, v12 op_sel_hi:[1,0,0]
    v_fma_mix_f32 v13, v82, v102, v13 op_sel:[1,0,0] op_sel_hi:[1,0,0]
    v_fma_mix_f32 v14, v83, v102, v14 op_sel_hi:[1,0,0]
    v_fma_mix_f32 v15, v83, v102, v15 op_sel:[1,0,0] op_sel_hi:[1,0,0]
    v_fma_mix_f32 v16, v84, v102, v16 op_sel_hi:[1,0,0]
    v_fma_mix_f32 v17, v84, v102, v17 op_sel:[1,0,0] op_sel_hi:[1,0,0]
    v_fma_mix_f32 v18, v85, v102, v18 op_sel_hi:[1,0,0]
    v_fma_mix_f32 v19, v85, v102, v19 op_sel:[1,0,0] op_sel_hi:[1,0,0]
    v_fma_mix_f32 v20, v86, v102, v20 op_sel_hi:[1,0,0]
    v_fma_mix_f32 v21, v86, v102, v21 op_sel:[1,0,0] op_sel_hi:[1,0,0]
    v_fma_mix_f32 v22, v87, v102, v22 op_sel_hi:[1,0,0]
    v_fma_mix_f32 v23, v87, v102, v23 op_sel:[1,0,0] op_sel_hi:[1,0,0]
    s_waitcnt vmcnt(0)
    v_fma_mix_f32 v8, v88, v103, v8 op_sel_hi:[1,0,0]
    v_fma_mix_f32 v9, v88, v103, v9 op_sel:[1,0,0] op_sel_hi:[1,0,0]
    v_fma_mix_f32 v10, v89, v103, v10 op_sel_hi:[1,0,0]
    v_fma_mix_f32 v11, v89, v103, v11 op_sel:[1,0,0] op_sel_hi:[1,0,0]
    v_fma_mix_f32 v12, v90, v103, v12 op_sel_hi:[1,0,0]
    v_fma_mix_f32 v13, v90, v103, v13 op_sel:[1,0,0] op_sel_hi:[1,0,0]
    v_fma_mix_f32 v14, v91, v103, v14 op_sel_hi:[1,0,0]
    v_fma_mix_f32 v15, v91, v103, v15 op_sel:[1,0,0] op_sel_hi:[1,0,0]
    v_fma_mix_f32 v16, v92, v103, v16 op_sel_hi:[1,0,0]
    v_fma_mix_f32 v17, v92, v103, v17 op_sel:[1,0,0] op_sel_hi:[1,0,0]
    v_fma_mix_f32 v18, v93, v103, v18 op_sel_hi:[1,0,0]
    v_fma_mix_f32 v19, v93, v103, v19 op_sel:[1,0,0] op_sel_hi:[1,0,0]
    v_fma_mix_f32 v20, v94, v103, v20 op_sel_hi:[1,0,0]
    v_fma_mix_f32 v21, v94, v103, v21 op_sel:[1,0,0] op_sel_hi:[1,0,0]
    v_fma_mix_f32 v22, v95, v103, v22 op_sel_hi:[1,0,0]
    v_fma_mix_f32 v23, v95, v103, v23 op_sel:[1,0,0] op_sel_hi:[1,0,0]
    v_cvt_pk_bf16_f32 v24, v8, v9
    v_cvt_pk_bf16_f32 v25, v10, v11
    v_cvt_pk_bf16_f32 v26, v12, v13
    v_cvt_pk_bf16_f32 v27, v14, v15
    buffer_store_dwordx4 v[24:27], v4, s[8:11], s27 offen offset:0
    v_cvt_pk_bf16_f32 v28, v16, v17
    v_cvt_pk_bf16_f32 v29, v18, v19
    v_cvt_pk_bf16_f32 v30, v20, v21
    v_cvt_pk_bf16_f32 v31, v22, v23
    buffer_store_dwordx4 v[28:31], v4, s[8:11], s27 offen offset:16
reduce_done:
    s_endpgm
.section .rodata,"a"
.p2align 6
.amdhsa_kernel main_kernel
  .amdhsa_next_free_vgpr 512
  .amdhsa_next_free_sgpr 102
  .amdhsa_accum_offset 256
  .amdhsa_group_segment_fixed_size 0
  .amdhsa_kernarg_size 104
  .amdhsa_user_sgpr_count 2
  .amdhsa_user_sgpr_kernarg_segment_ptr 1
  .amdhsa_system_sgpr_workgroup_id_x 1
.end_amdhsa_kernel
.p2align 6
.amdhsa_kernel reduce_kernel
  .amdhsa_next_free_vgpr 144
  .amdhsa_next_free_sgpr 32
  .amdhsa_accum_offset 144
  .amdhsa_group_segment_fixed_size 0
  .amdhsa_kernarg_size 104
  .amdhsa_user_sgpr_count 2
  .amdhsa_user_sgpr_kernarg_segment_ptr 1
  .amdhsa_system_sgpr_workgroup_id_x 1
.end_amdhsa_kernel
```
